```python
import torch

def _softmax(x, axis=-1):
    return torch.softmax(x, dim=axis)
def _gelu(x):
    return torch.nn.functional.gelu(x, approximate="tanh")
def _silu(x):
    return torch.nn.functional.silu(x)
def _sigmoid(x):
    return torch.sigmoid(x)
def _layernorm(x, axis=-1, eps=1e-5):
    m = x.mean(dim=axis, keepdim=True)
    v = x.var(dim=axis, keepdim=True, unbiased=False)
    return (x - m) / torch.sqrt(v + eps)
def _scatter_add(tgt, idx, src, axis=0):
    return tgt.clone().index_add_(axis, idx, src)
def _segment_sum(src, seg, n):
    out = torch.zeros((n,) + src.shape[1:], dtype=src.dtype)
    return out.index_add_(0, seg, src)
def _pad(x, pw):
    flat = tuple(v for pair in reversed(pw) for v in pair)
    return torch.nn.functional.pad(x, flat)

kernel_name = 'sequential_preLN__linear_attn_block__glu_gated_bilinear__prompt'

def setup_inputs():

    _w = (lambda a: (lambda t: t.to(torch.bfloat16) if t.is_floating_point() else t)(torch.as_tensor(a)))
    def _A_setup():
        B, S, D = 1, 2048, 512
        return {
            "x": _w((lambda *s: torch.randn(*s, dtype=torch.bfloat16) * 0.05)(B, S, D)),
            "wqkv": _w((lambda *s: torch.randn(*s, dtype=torch.bfloat16) * 0.05)(D, 3 * D)),
            "wo": _w((lambda *s: torch.randn(*s, dtype=torch.bfloat16) * 0.05)(D, D)),
        }
    _A_in = _A_setup()

    def _B_setup():
        B, S, D, F = 1, 2048, 512, 1376
        return {
            "x": _w((lambda *s: torch.randn(*s, dtype=torch.bfloat16) * 0.05)(B, S, D)),
            "w_gate": _w((lambda *s: torch.randn(*s, dtype=torch.bfloat16) * 0.2)(D, F) * (D ** -0.5)),
            "w_up": _w((lambda *s: torch.randn(*s, dtype=torch.bfloat16) * 0.2)(D, F) * (D ** -0.5)),
            "w_down": _w((lambda *s: torch.randn(*s, dtype=torch.bfloat16) * 0.2)(F, D) * (F ** -0.5)),
        }
    _B_in = _B_setup()

    return {
        "A_x": _A_in["x"],
        "A_wqkv": _A_in["wqkv"],
        "A_wo": _A_in["wo"],
        "B_x": _B_in["x"],
        "B_w_gate": _B_in["w_gate"],
        "B_w_up": _B_in["w_up"],
        "B_w_down": _B_in["w_down"],
    }

def reference(A_x, A_wqkv, A_wo, B_x, B_w_gate, B_w_up, B_w_down):
    def _A_ref(x, wqkv, wo):
        B, S, D = x.shape
        H = 32; Dh = D // H
        qkv = (lambda x, *d: x.permute(*d))((x @ wqkv).reshape(B, S, 3, H, Dh), 2, 0, 3, 1, 4)
        q, k, v = qkv[0], qkv[1], qkv[2]
        phi = lambda t: torch.where(t > 0, t + 1, torch.exp(t)) + 1e-6
        pq, pk = phi(q), phi(k)
        kv = torch.einsum("bhsd,bhse->bhde", pk, v)
        z = torch.einsum("bhsd->bhd", pk)
        num = torch.einsum("bhqd,bhde->bhqe", pq, kv)
        den = torch.einsum("bhqd,bhd->bhq", pq, z)[..., None] + 1e-6
        o = num / den
        return (lambda x, *d: x.permute(*d))(o, 0, 2, 1, 3).reshape(B, S, D) @ wo

    def _B_ref(x, w_gate, w_up, w_down):
        g = torch.einsum("bsd,df->bsf", x, w_gate)
        u = torch.einsum("bsd,df->bsf", x, w_up)
        h = g * u
        return torch.einsum("bsf,fd->bsd", h, w_down)

    x = A_x
    h = x + _A_ref(_layernorm(x, axis=-1), A_wqkv, A_wo)
    h2 = h + _B_ref(_layernorm(h, axis=-1), B_w_gate, B_w_up, B_w_down)
    return h2
```

```asm
; @launch kernel=k1_qkv_kernel grid=(256,1,1) block=(512,1,1) lds=133120
; @launch kernel=kr_reduce_kernel grid=(32,1,1) block=(256,1,1) lds=0
; @launch kernel=k2_attnout_kernel grid=(256,1,1) block=(512,1,1) lds=65536
; @launch kernel=k3_gateup_kernel grid=(240,1,1) block=(512,1,1) lds=149504
; @launch kernel=sequential_preLN__linear_attn_block__glu_gated_bilinear__prompt_kernel grid=(256,1,1) block=(512,1,1) lds=131072
.amdgcn_target "amdgcn-amd-amdhsa--gfx950"
.text
.p2align 8
.globl k1_qkv_kernel
.type k1_qkv_kernel,@function
k1_qkv_kernel:
    s_cmp_ge_u32 s2, 256
    s_cbranch_scc1 K1_END
    s_load_dwordx2 s[4:5], s[0:1], 0
    s_load_dwordx2 s[6:7], s[0:1], 8
    s_load_dwordx2 s[8:9], s[0:1], 72
    s_load_dwordx2 s[10:11], s[0:1], 16
    s_load_dwordx4 s[40:43], s[0:1], 32
    v_and_b32 v1, 63, v0
    v_lshrrev_b32 v4, 6, v0
    s_nop 0
    v_readfirstlane_b32 s24, v4
    v_and_b32 v2, 31, v1
    v_lshrrev_b32 v3, 5, v1
    s_and_b32 s34, s24, 3
    s_lshr_b32 s35, s24, 2
    s_and_b32 s25, s2, 7
    s_lshl_b32 s25, s25, 1
    s_bfe_u32 s26, s2, 0x10003
    s_or_b32 s25, s25, s26
    s_lshr_b32 s26, s2, 4
    s_waitcnt lgkmcnt(0)
    s_mov_b32 s12, s4
    s_mov_b32 s13, s5
    s_mov_b32 s14, 0x200000
    s_mov_b32 s15, 0x00020000
    s_mov_b32 s16, s6
    s_mov_b32 s17, s7
    s_mov_b32 s18, 0x180000
    s_mov_b32 s19, 0x00020000
    s_mov_b32 s20, s8
    s_mov_b32 s21, s9
    s_mov_b32 s22, 0xb60000
    s_mov_b32 s23, 0x00020000
    s_mov_b32 s44, s10
    s_mov_b32 s45, s11
    s_mov_b32 s46, 0x80000
    s_mov_b32 s47, 0x00020000
    s_mov_b32 s48, s40
    s_mov_b32 s49, s41
    s_mov_b32 s50, 0x158000
    s_mov_b32 s51, 0x00020000
    s_mov_b32 s52, s42
    s_mov_b32 s53, s43
    s_mov_b32 s54, 0x158000
    s_mov_b32 s55, 0x00020000
    s_lshl_b32 s27, s25, 7
    s_lshl_b32 s28, s34, 5
    s_add_u32 s27, s27, s28
    v_lshrrev_b32 v8, 3, v1
    v_and_b32 v11, 7, v1
    v_add_u32 v9, s27, v8
    v_lshlrev_b32 v9, 10, v9
    v_lshl_add_u32 v9, v11, 4, v9
    s_lshl_b32 s28, s35, 7
    v_add_u32 v9, s28, v9
    s_mov_b32 s31, 0
    buffer_load_dwordx4 v[16:19], v9, s[12:15], s31 offen offset:0
    s_mov_b32 s31, 8192
    buffer_load_dwordx4 v[32:35], v9, s[12:15], s31 offen offset:0
    s_mov_b32 s31, 16384
    buffer_load_dwordx4 v[48:51], v9, s[12:15], s31 offen offset:0
    s_mov_b32 s31, 24576
    buffer_load_dwordx4 v[64:67], v9, s[12:15], s31 offen offset:0
    s_mov_b32 s31, 0
    buffer_load_dwordx4 v[20:23], v9, s[12:15], s31 offen offset:256
    s_mov_b32 s31, 8192
    buffer_load_dwordx4 v[36:39], v9, s[12:15], s31 offen offset:256
    s_mov_b32 s31, 16384
    buffer_load_dwordx4 v[52:55], v9, s[12:15], s31 offen offset:256
    s_mov_b32 s31, 24576
    buffer_load_dwordx4 v[68:71], v9, s[12:15], s31 offen offset:256
    s_mov_b32 s31, 0
    buffer_load_dwordx4 v[24:27], v9, s[12:15], s31 offen offset:512
    s_mov_b32 s31, 8192
    buffer_load_dwordx4 v[40:43], v9, s[12:15], s31 offen offset:512
    s_mov_b32 s31, 16384
    buffer_load_dwordx4 v[56:59], v9, s[12:15], s31 offen offset:512
    s_mov_b32 s31, 24576
    buffer_load_dwordx4 v[72:75], v9, s[12:15], s31 offen offset:512
    s_mov_b32 s31, 0
    buffer_load_dwordx4 v[28:31], v9, s[12:15], s31 offen offset:768
    s_mov_b32 s31, 8192
    buffer_load_dwordx4 v[44:47], v9, s[12:15], s31 offen offset:768
    s_mov_b32 s31, 16384
    buffer_load_dwordx4 v[60:63], v9, s[12:15], s31 offen offset:768
    s_mov_b32 s31, 24576
    buffer_load_dwordx4 v[76:79], v9, s[12:15], s31 offen offset:768
    v_lshrrev_b32 v10, 2, v1
    s_lshl_b32 s28, s24, 4
    v_add_u32 v10, s28, v10
    s_movk_i32 s29, 3072
    v_mul_lo_u32 v10, v10, s29
    v_and_b32 v14, 3, v1
    v_lshl_add_u32 v10, v14, 4, v10
    s_lshl_b32 s29, s26, 6
    v_add_u32 v10, s29, v10
    s_lshl_b32 s30, s24, 10
    s_mov_b32 s31, 0
    s_add_u32 m0, s30, 0
    s_nop 0
    buffer_load_dwordx4 v10, s[16:19], s31 offen lds
    s_mov_b32 s31, 1024
    s_add_u32 m0, s30, 32768
    s_nop 0
    buffer_load_dwordx4 v10, s[16:19], s31 offen lds
    s_mov_b32 s31, 2048
    s_add_u32 m0, s30, 65536
    s_nop 0
    buffer_load_dwordx4 v10, s[16:19], s31 offen lds
    s_mov_b32 s31, 393216
    s_add_u32 m0, s30, 8192
    s_nop 0
    buffer_load_dwordx4 v10, s[16:19], s31 offen lds
    s_mov_b32 s31, 394240
    s_add_u32 m0, s30, 40960
    s_nop 0
    buffer_load_dwordx4 v10, s[16:19], s31 offen lds
    s_mov_b32 s31, 395264
    s_add_u32 m0, s30, 73728
    s_nop 0
    buffer_load_dwordx4 v10, s[16:19], s31 offen lds
    v_bfe_u32 v5, v1, 2, 2
    v_and_b32 v6, 3, v1
    v_bfe_u32 v7, v1, 4, 1
    v_lshl_add_u32 v12, v3, 3, v5
    v_lshlrev_b32 v12, 6, v12
    v_lshl_add_u32 v12, v7, 5, v12
    v_lshl_add_u32 v12, v6, 3, v12
    v_add_u32 v13, 0x10000, v12
    s_lshl_b32 s28, s24, 12
    s_add_u32 s28, s28, 98304
    v_add_u32 v14, 0, v8
    v_bfe_u32 v15, v14, 1, 3
    v_xor_b32 v15, v15, v11
    v_lshlrev_b32 v15, 4, v15
    v_lshl_add_u32 v128, v14, 7, v15
    v_add_u32 v128, s28, v128
    v_add_u32 v14, 8, v8
    v_bfe_u32 v15, v14, 1, 3
    v_xor_b32 v15, v15, v11
    v_lshlrev_b32 v15, 4, v15
    v_lshl_add_u32 v129, v14, 7, v15
    v_add_u32 v129, s28, v129
    v_add_u32 v14, 16, v8
    v_bfe_u32 v15, v14, 1, 3
    v_xor_b32 v15, v15, v11
    v_lshlrev_b32 v15, 4, v15
    v_lshl_add_u32 v130, v14, 7, v15
    v_add_u32 v130, s28, v130
    v_add_u32 v14, 24, v8
    v_bfe_u32 v15, v14, 1, 3
    v_xor_b32 v15, v15, v11
    v_lshlrev_b32 v15, 4, v15
    v_lshl_add_u32 v131, v14, 7, v15
    v_add_u32 v131, s28, v131
    v_add_u32 v14, 0, v3
    v_bfe_u32 v15, v2, 1, 3
    v_xor_b32 v15, v15, v14
    v_lshlrev_b32 v15, 4, v15
    v_lshl_add_u32 v132, v2, 7, v15
    v_add_u32 v132, s28, v132
    v_add_u32 v14, 2, v3
    v_bfe_u32 v15, v2, 1, 3
    v_xor_b32 v15, v15, v14
    v_lshlrev_b32 v15, 4, v15
    v_lshl_add_u32 v133, v2, 7, v15
    v_add_u32 v133, s28, v133
    v_add_u32 v14, 4, v3
    v_bfe_u32 v15, v2, 1, 3
    v_xor_b32 v15, v15, v14
    v_lshlrev_b32 v15, 4, v15
    v_lshl_add_u32 v134, v2, 7, v15
    v_add_u32 v134, s28, v134
    v_add_u32 v14, 6, v3
    v_bfe_u32 v15, v2, 1, 3
    v_xor_b32 v15, v15, v14
    v_lshlrev_b32 v15, 4, v15
    v_lshl_add_u32 v135, v2, 7, v15
    v_add_u32 v135, s28, v135
    s_waitcnt vmcnt(6)
    v_mov_b32 v152, 0x3f803f80
    v_mov_b32 v144, 0
    v_mov_b32 v148, 0
    v_mov_b32 v145, 0
    v_mov_b32 v149, 0
    v_mov_b32 v146, 0
    v_mov_b32 v150, 0
    v_mov_b32 v147, 0
    v_mov_b32 v151, 0
    v_dot2c_f32_bf16 v144, v16, v152
    v_dot2c_f32_bf16 v148, v16, v16
    v_dot2c_f32_bf16 v145, v32, v152
    v_dot2c_f32_bf16 v149, v32, v32
    v_dot2c_f32_bf16 v146, v48, v152
    v_dot2c_f32_bf16 v150, v48, v48
    v_dot2c_f32_bf16 v147, v64, v152
    v_dot2c_f32_bf16 v151, v64, v64
    v_dot2c_f32_bf16 v144, v17, v152
    v_dot2c_f32_bf16 v148, v17, v17
    v_dot2c_f32_bf16 v145, v33, v152
    v_dot2c_f32_bf16 v149, v33, v33
    v_dot2c_f32_bf16 v146, v49, v152
    v_dot2c_f32_bf16 v150, v49, v49
    v_dot2c_f32_bf16 v147, v65, v152
    v_dot2c_f32_bf16 v151, v65, v65
    v_dot2c_f32_bf16 v144, v18, v152
    v_dot2c_f32_bf16 v148, v18, v18
    v_dot2c_f32_bf16 v145, v34, v152
    v_dot2c_f32_bf16 v149, v34, v34
    v_dot2c_f32_bf16 v146, v50, v152
    v_dot2c_f32_bf16 v150, v50, v50
    v_dot2c_f32_bf16 v147, v66, v152
    v_dot2c_f32_bf16 v151, v66, v66
    v_dot2c_f32_bf16 v144, v19, v152
    v_dot2c_f32_bf16 v148, v19, v19
    v_dot2c_f32_bf16 v145, v35, v152
    v_dot2c_f32_bf16 v149, v35, v35
    v_dot2c_f32_bf16 v146, v51, v152
    v_dot2c_f32_bf16 v150, v51, v51
    v_dot2c_f32_bf16 v147, v67, v152
    v_dot2c_f32_bf16 v151, v67, v67
    v_dot2c_f32_bf16 v144, v20, v152
    v_dot2c_f32_bf16 v148, v20, v20
    v_dot2c_f32_bf16 v145, v36, v152
    v_dot2c_f32_bf16 v149, v36, v36
    v_dot2c_f32_bf16 v146, v52, v152
    v_dot2c_f32_bf16 v150, v52, v52
    v_dot2c_f32_bf16 v147, v68, v152
    v_dot2c_f32_bf16 v151, v68, v68
    v_dot2c_f32_bf16 v144, v21, v152
    v_dot2c_f32_bf16 v148, v21, v21
    v_dot2c_f32_bf16 v145, v37, v152
    v_dot2c_f32_bf16 v149, v37, v37
    v_dot2c_f32_bf16 v146, v53, v152
    v_dot2c_f32_bf16 v150, v53, v53
    v_dot2c_f32_bf16 v147, v69, v152
    v_dot2c_f32_bf16 v151, v69, v69
    v_dot2c_f32_bf16 v144, v22, v152
    v_dot2c_f32_bf16 v148, v22, v22
    v_dot2c_f32_bf16 v145, v38, v152
    v_dot2c_f32_bf16 v149, v38, v38
    v_dot2c_f32_bf16 v146, v54, v152
    v_dot2c_f32_bf16 v150, v54, v54
    v_dot2c_f32_bf16 v147, v70, v152
    v_dot2c_f32_bf16 v151, v70, v70
    v_dot2c_f32_bf16 v144, v23, v152
    v_dot2c_f32_bf16 v148, v23, v23
    v_dot2c_f32_bf16 v145, v39, v152
    v_dot2c_f32_bf16 v149, v39, v39
    v_dot2c_f32_bf16 v146, v55, v152
    v_dot2c_f32_bf16 v150, v55, v55
    v_dot2c_f32_bf16 v147, v71, v152
    v_dot2c_f32_bf16 v151, v71, v71
    v_dot2c_f32_bf16 v144, v24, v152
    v_dot2c_f32_bf16 v148, v24, v24
    v_dot2c_f32_bf16 v145, v40, v152
    v_dot2c_f32_bf16 v149, v40, v40
    v_dot2c_f32_bf16 v146, v56, v152
    v_dot2c_f32_bf16 v150, v56, v56
    v_dot2c_f32_bf16 v147, v72, v152
    v_dot2c_f32_bf16 v151, v72, v72
    v_dot2c_f32_bf16 v144, v25, v152
    v_dot2c_f32_bf16 v148, v25, v25
    v_dot2c_f32_bf16 v145, v41, v152
    v_dot2c_f32_bf16 v149, v41, v41
    v_dot2c_f32_bf16 v146, v57, v152
    v_dot2c_f32_bf16 v150, v57, v57
    v_dot2c_f32_bf16 v147, v73, v152
    v_dot2c_f32_bf16 v151, v73, v73
    v_dot2c_f32_bf16 v144, v26, v152
    v_dot2c_f32_bf16 v148, v26, v26
    v_dot2c_f32_bf16 v145, v42, v152
    v_dot2c_f32_bf16 v149, v42, v42
    v_dot2c_f32_bf16 v146, v58, v152
    v_dot2c_f32_bf16 v150, v58, v58
    v_dot2c_f32_bf16 v147, v74, v152
    v_dot2c_f32_bf16 v151, v74, v74
    v_dot2c_f32_bf16 v144, v27, v152
    v_dot2c_f32_bf16 v148, v27, v27
    v_dot2c_f32_bf16 v145, v43, v152
    v_dot2c_f32_bf16 v149, v43, v43
    v_dot2c_f32_bf16 v146, v59, v152
    v_dot2c_f32_bf16 v150, v59, v59
    v_dot2c_f32_bf16 v147, v75, v152
    v_dot2c_f32_bf16 v151, v75, v75
    v_dot2c_f32_bf16 v144, v28, v152
    v_dot2c_f32_bf16 v148, v28, v28
    v_dot2c_f32_bf16 v145, v44, v152
    v_dot2c_f32_bf16 v149, v44, v44
    v_dot2c_f32_bf16 v146, v60, v152
    v_dot2c_f32_bf16 v150, v60, v60
    v_dot2c_f32_bf16 v147, v76, v152
    v_dot2c_f32_bf16 v151, v76, v76
    v_dot2c_f32_bf16 v144, v29, v152
    v_dot2c_f32_bf16 v148, v29, v29
    v_dot2c_f32_bf16 v145, v45, v152
    v_dot2c_f32_bf16 v149, v45, v45
    v_dot2c_f32_bf16 v146, v61, v152
    v_dot2c_f32_bf16 v150, v61, v61
    v_dot2c_f32_bf16 v147, v77, v152
    v_dot2c_f32_bf16 v151, v77, v77
    v_dot2c_f32_bf16 v144, v30, v152
    v_dot2c_f32_bf16 v148, v30, v30
    v_dot2c_f32_bf16 v145, v46, v152
    v_dot2c_f32_bf16 v149, v46, v46
    v_dot2c_f32_bf16 v146, v62, v152
    v_dot2c_f32_bf16 v150, v62, v62
    v_dot2c_f32_bf16 v147, v78, v152
    v_dot2c_f32_bf16 v151, v78, v78
    v_dot2c_f32_bf16 v144, v31, v152
    v_dot2c_f32_bf16 v148, v31, v31
    v_dot2c_f32_bf16 v145, v47, v152
    v_dot2c_f32_bf16 v149, v47, v47
    v_dot2c_f32_bf16 v146, v63, v152
    v_dot2c_f32_bf16 v150, v63, v63
    v_dot2c_f32_bf16 v147, v79, v152
    v_dot2c_f32_bf16 v151, v79, v79
    s_nop 3
    v_add_f32_dpp v144, v144, v144 quad_perm:[1,0,3,2] row_mask:0xf bank_mask:0xf
    v_add_f32_dpp v145, v145, v145 quad_perm:[1,0,3,2] row_mask:0xf bank_mask:0xf
    v_add_f32_dpp v146, v146, v146 quad_perm:[1,0,3,2] row_mask:0xf bank_mask:0xf
    v_add_f32_dpp v147, v147, v147 quad_perm:[1,0,3,2] row_mask:0xf bank_mask:0xf
    v_add_f32_dpp v148, v148, v148 quad_perm:[1,0,3,2] row_mask:0xf bank_mask:0xf
    v_add_f32_dpp v149, v149, v149 quad_perm:[1,0,3,2] row_mask:0xf bank_mask:0xf
    v_add_f32_dpp v150, v150, v150 quad_perm:[1,0,3,2] row_mask:0xf bank_mask:0xf
    v_add_f32_dpp v151, v151, v151 quad_perm:[1,0,3,2] row_mask:0xf bank_mask:0xf
    s_nop 1
    v_add_f32_dpp v144, v144, v144 quad_perm:[2,3,0,1] row_mask:0xf bank_mask:0xf
    v_add_f32_dpp v145, v145, v145 quad_perm:[2,3,0,1] row_mask:0xf bank_mask:0xf
    v_add_f32_dpp v146, v146, v146 quad_perm:[2,3,0,1] row_mask:0xf bank_mask:0xf
    v_add_f32_dpp v147, v147, v147 quad_perm:[2,3,0,1] row_mask:0xf bank_mask:0xf
    v_add_f32_dpp v148, v148, v148 quad_perm:[2,3,0,1] row_mask:0xf bank_mask:0xf
    v_add_f32_dpp v149, v149, v149 quad_perm:[2,3,0,1] row_mask:0xf bank_mask:0xf
    v_add_f32_dpp v150, v150, v150 quad_perm:[2,3,0,1] row_mask:0xf bank_mask:0xf
    v_add_f32_dpp v151, v151, v151 quad_perm:[2,3,0,1] row_mask:0xf bank_mask:0xf
    s_nop 1
    v_add_f32_dpp v144, v144, v144 row_half_mirror row_mask:0xf bank_mask:0xf
    v_add_f32_dpp v145, v145, v145 row_half_mirror row_mask:0xf bank_mask:0xf
    v_add_f32_dpp v146, v146, v146 row_half_mirror row_mask:0xf bank_mask:0xf
    v_add_f32_dpp v147, v147, v147 row_half_mirror row_mask:0xf bank_mask:0xf
    v_add_f32_dpp v148, v148, v148 row_half_mirror row_mask:0xf bank_mask:0xf
    v_add_f32_dpp v149, v149, v149 row_half_mirror row_mask:0xf bank_mask:0xf
    v_add_f32_dpp v150, v150, v150 row_half_mirror row_mask:0xf bank_mask:0xf
    v_add_f32_dpp v151, v151, v151 row_half_mirror row_mask:0xf bank_mask:0xf
    s_nop 1
    s_lshl_b32 s28, s24, 8
    s_add_u32 s28, s28, 131072
    v_lshlrev_b32 v14, 3, v8
    v_add_u32 v14, s28, v14
    s_xor_b32 s28, s28, 0x400
    v_lshlrev_b32 v15, 3, v8
    v_add_u32 v15, s28, v15
    v_mov_b32 v154, v144
    v_mov_b32 v155, v148
    v_mov_b32 v156, v145
    v_mov_b32 v157, v149
    v_mov_b32 v158, v146
    v_mov_b32 v159, v150
    v_mov_b32 v160, v147
    v_mov_b32 v161, v151
    ds_write_b64 v14, v[154:155] offset:0
    ds_write_b64 v14, v[156:157] offset:64
    ds_write_b64 v14, v[158:159] offset:128
    ds_write_b64 v14, v[160:161] offset:192
    s_waitcnt lgkmcnt(0)
    s_barrier
    ds_read_b64 v[154:155], v15 offset:0
    ds_read_b64 v[156:157], v15 offset:64
    ds_read_b64 v[158:159], v15 offset:128
    ds_read_b64 v[160:161], v15 offset:192
    s_waitcnt lgkmcnt(0)
    v_add_f32 v144, v144, v154
    v_add_f32 v148, v148, v155
    v_add_f32 v145, v145, v156
    v_add_f32 v149, v149, v157
    v_add_f32 v146, v146, v158
    v_add_f32 v150, v150, v159
    v_add_f32 v147, v147, v160
    v_add_f32 v151, v151, v161
    v_mul_f32 v144, 0x3b000000, v144
    v_mul_f32 v148, 0x3b000000, v148
    v_mul_f32 v145, 0x3b000000, v145
    v_mul_f32 v149, 0x3b000000, v149
    v_mul_f32 v146, 0x3b000000, v146
    v_mul_f32 v150, 0x3b000000, v150
    v_mul_f32 v147, 0x3b000000, v147
    v_mul_f32 v151, 0x3b000000, v151
    v_fma_f32 v148, -v144, v144, v148
    v_fma_f32 v149, -v145, v145, v149
    v_fma_f32 v150, -v146, v146, v150
    v_fma_f32 v151, -v147, v147, v151
    v_max_f32 v148, 0, v148
    v_max_f32 v149, 0, v149
    v_max_f32 v150, 0, v150
    v_max_f32 v151, 0, v151
    v_add_f32 v148, 0x3727c5ac, v148
    v_add_f32 v149, 0x3727c5ac, v149
    v_add_f32 v150, 0x3727c5ac, v150
    v_add_f32 v151, 0x3727c5ac, v151
    v_rsq_f32 v136, v148
    v_rsq_f32 v137, v149
    v_rsq_f32 v138, v150
    v_rsq_f32 v139, v151
    s_nop 0
    v_mul_f32 v140, v144, v136
    v_mul_f32 v141, v145, v137
    v_mul_f32 v142, v146, v138
    v_mul_f32 v143, v147, v139
    v_sub_f32 v140, 0, v140
    v_sub_f32 v141, 0, v141
    v_sub_f32 v142, 0, v142
    v_sub_f32 v143, 0, v143
    s_lshl_b32 s28, s35, 12
    v_add_u32 v12, s28, v12
    v_add_u32 v13, s28, v13
    v_lshlrev_b32 v164, 16, v16
    v_lshlrev_b32 v166, 16, v17
    v_lshlrev_b32 v168, 16, v18
    v_lshlrev_b32 v170, 16, v19
    v_and_b32 v165, 0xffff0000, v16
    v_and_b32 v167, 0xffff0000, v17
    v_and_b32 v169, 0xffff0000, v18
    v_and_b32 v171, 0xffff0000, v19
    v_fma_f32 v164, v164, v136, v140
    v_fma_f32 v166, v166, v136, v140
    v_fma_f32 v168, v168, v136, v140
    v_fma_f32 v170, v170, v136, v140
    v_fma_f32 v165, v165, v136, v140
    v_fma_f32 v167, v167, v136, v140
    v_fma_f32 v169, v169, v136, v140
    v_fma_f32 v171, v171, v136, v140
    v_cvt_pk_bf16_f32 v16, v164, v165
    v_cvt_pk_bf16_f32 v17, v166, v167
    v_cvt_pk_bf16_f32 v18, v168, v169
    v_cvt_pk_bf16_f32 v19, v170, v171
    ds_write_b128 v128, v[16:19]
    v_lshlrev_b32 v164, 16, v32
    v_lshlrev_b32 v166, 16, v33
    v_lshlrev_b32 v168, 16, v34
    v_lshlrev_b32 v170, 16, v35
    v_and_b32 v165, 0xffff0000, v32
    v_and_b32 v167, 0xffff0000, v33
    v_and_b32 v169, 0xffff0000, v34
    v_and_b32 v171, 0xffff0000, v35
    v_fma_f32 v164, v164, v137, v141
    v_fma_f32 v166, v166, v137, v141
    v_fma_f32 v168, v168, v137, v141
    v_fma_f32 v170, v170, v137, v141
    v_fma_f32 v165, v165, v137, v141
    v_fma_f32 v167, v167, v137, v141
    v_fma_f32 v169, v169, v137, v141
    v_fma_f32 v171, v171, v137, v141
    v_cvt_pk_bf16_f32 v32, v164, v165
    v_cvt_pk_bf16_f32 v33, v166, v167
    v_cvt_pk_bf16_f32 v34, v168, v169
    v_cvt_pk_bf16_f32 v35, v170, v171
    ds_write_b128 v129, v[32:35]
    v_lshlrev_b32 v164, 16, v48
    v_lshlrev_b32 v166, 16, v49
    v_lshlrev_b32 v168, 16, v50
    v_lshlrev_b32 v170, 16, v51
    v_and_b32 v165, 0xffff0000, v48
    v_and_b32 v167, 0xffff0000, v49
    v_and_b32 v169, 0xffff0000, v50
    v_and_b32 v171, 0xffff0000, v51
    v_fma_f32 v164, v164, v138, v142
    v_fma_f32 v166, v166, v138, v142
    v_fma_f32 v168, v168, v138, v142
    v_fma_f32 v170, v170, v138, v142
    v_fma_f32 v165, v165, v138, v142
    v_fma_f32 v167, v167, v138, v142
    v_fma_f32 v169, v169, v138, v142
    v_fma_f32 v171, v171, v138, v142
    v_cvt_pk_bf16_f32 v48, v164, v165
    v_cvt_pk_bf16_f32 v49, v166, v167
    v_cvt_pk_bf16_f32 v50, v168, v169
    v_cvt_pk_bf16_f32 v51, v170, v171
    ds_write_b128 v130, v[48:51]
    v_lshlrev_b32 v164, 16, v64
    v_lshlrev_b32 v166, 16, v65
    v_lshlrev_b32 v168, 16, v66
    v_lshlrev_b32 v170, 16, v67
    v_and_b32 v165, 0xffff0000, v64
    v_and_b32 v167, 0xffff0000, v65
    v_and_b32 v169, 0xffff0000, v66
    v_and_b32 v171, 0xffff0000, v67
    v_fma_f32 v164, v164, v139, v143
    v_fma_f32 v166, v166, v139, v143
    v_fma_f32 v168, v168, v139, v143
    v_fma_f32 v170, v170, v139, v143
    v_fma_f32 v165, v165, v139, v143
    v_fma_f32 v167, v167, v139, v143
    v_fma_f32 v169, v169, v139, v143
    v_fma_f32 v171, v171, v139, v143
    v_cvt_pk_bf16_f32 v64, v164, v165
    v_cvt_pk_bf16_f32 v65, v166, v167
    v_cvt_pk_bf16_f32 v66, v168, v169
    v_cvt_pk_bf16_f32 v67, v170, v171
    ds_write_b128 v131, v[64:67]
    ds_read_b128 a[0:3], v132
    ds_read_b128 a[4:7], v133
    ds_read_b128 a[8:11], v134
    ds_read_b128 a[12:15], v135
    s_waitcnt vmcnt(3)
    s_barrier
    ds_read_b64_tr_b16 a[16:17], v12 offset:0
    ds_read_b64_tr_b16 a[18:19], v12 offset:256
    ds_read_b64_tr_b16 a[20:21], v12 offset:32768
    ds_read_b64_tr_b16 a[22:23], v12 offset:33024
    ds_read_b64_tr_b16 a[24:25], v13 offset:0
    ds_read_b64_tr_b16 a[26:27], v13 offset:256
    s_waitcnt lgkmcnt(0)
    v_mfma_f32_32x32x16_bf16 v[80:95], a[16:19], a[0:3], 0
    ds_read_b64_tr_b16 a[28:29], v12 offset:1024
    v_lshlrev_b32 v164, 16, v20
    v_lshlrev_b32 v166, 16, v21
    v_lshlrev_b32 v168, 16, v22
    v_lshlrev_b32 v170, 16, v23
    v_and_b32 v165, 0xffff0000, v20
    v_and_b32 v167, 0xffff0000, v21
    ds_read_b64_tr_b16 a[30:31], v12 offset:1280
    v_and_b32 v169, 0xffff0000, v22
    v_and_b32 v171, 0xffff0000, v23
    v_fma_f32 v164, v164, v136, v140
    v_fma_f32 v166, v166, v136, v140
    v_fma_f32 v168, v168, v136, v140
    v_mfma_f32_32x32x16_bf16 v[96:111], a[0:3], a[20:23], 0
    ds_read_b64_tr_b16 a[32:33], v12 offset:33792
    v_fma_f32 v170, v170, v136, v140
    v_fma_f32 v165, v165, v136, v140
    v_fma_f32 v167, v167, v136, v140
    v_fma_f32 v169, v169, v136, v140
    v_fma_f32 v171, v171, v136, v140
    v_cvt_pk_bf16_f32 v20, v164, v165
    ds_read_b64_tr_b16 a[34:35], v12 offset:34048
    v_cvt_pk_bf16_f32 v21, v166, v167
    v_cvt_pk_bf16_f32 v22, v168, v169
    v_cvt_pk_bf16_f32 v23, v170, v171
    ds_write_b128 v128, v[20:23]
    s_mov_b32 s31, 786432
    v_mfma_f32_32x32x16_bf16 v[112:127], a[0:3], a[24:27], 0
    ds_read_b64_tr_b16 a[36:37], v13 offset:1024
    s_add_u32 m0, s30, 16384
    s_nop 0
    buffer_load_dwordx4 v10, s[16:19], s31 offen lds
    s_mov_b32 s31, 787456
    s_add_u32 m0, s30, 49152
    s_nop 0
    ds_read_b64_tr_b16 a[38:39], v13 offset:1280
    buffer_load_dwordx4 v10, s[16:19], s31 offen lds
    s_mov_b32 s31, 788480
    s_add_u32 m0, s30, 81920
    s_nop 0
    buffer_load_dwordx4 v10, s[16:19], s31 offen lds
    s_waitcnt lgkmcnt(0)
    v_mfma_f32_32x32x16_bf16 v[80:95], a[28:31], a[4:7], v[80:95]
    ds_read_b64_tr_b16 a[16:17], v12 offset:2048
    v_lshlrev_b32 v164, 16, v36
    v_lshlrev_b32 v166, 16, v37
    v_lshlrev_b32 v168, 16, v38
    v_lshlrev_b32 v170, 16, v39
    ds_read_b64_tr_b16 a[18:19], v12 offset:2304
    v_and_b32 v165, 0xffff0000, v36
    v_and_b32 v167, 0xffff0000, v37
    v_and_b32 v169, 0xffff0000, v38
    v_mfma_f32_32x32x16_bf16 v[96:111], a[4:7], a[32:35], v[96:111]
    ds_read_b64_tr_b16 a[20:21], v12 offset:34816
    v_and_b32 v171, 0xffff0000, v39
    v_fma_f32 v164, v164, v137, v141
    v_fma_f32 v166, v166, v137, v141
    v_fma_f32 v168, v168, v137, v141
    ds_read_b64_tr_b16 a[22:23], v12 offset:35072
    v_fma_f32 v170, v170, v137, v141
    v_fma_f32 v165, v165, v137, v141
    v_fma_f32 v167, v167, v137, v141
    v_mfma_f32_32x32x16_bf16 v[112:127], a[4:7], a[36:39], v[112:127]
    ds_read_b64_tr_b16 a[24:25], v13 offset:2048
    v_fma_f32 v169, v169, v137, v141
    v_fma_f32 v171, v171, v137, v141
    v_cvt_pk_bf16_f32 v36, v164, v165
    v_cvt_pk_bf16_f32 v37, v166, v167
    ds_read_b64_tr_b16 a[26:27], v13 offset:2304
    v_cvt_pk_bf16_f32 v38, v168, v169
    v_cvt_pk_bf16_f32 v39, v170, v171
    ds_write_b128 v129, v[36:39]
    s_waitcnt lgkmcnt(1)
    v_mfma_f32_32x32x16_bf16 v[80:95], a[16:19], a[8:11], v[80:95]
    ds_read_b64_tr_b16 a[28:29], v12 offset:3072
    v_lshlrev_b32 v164, 16, v52
    v_lshlrev_b32 v166, 16, v53
    v_lshlrev_b32 v168, 16, v54
    v_lshlrev_b32 v170, 16, v55
    ds_read_b64_tr_b16 a[30:31], v12 offset:3328
    v_and_b32 v165, 0xffff0000, v52
    v_and_b32 v167, 0xffff0000, v53
    v_and_b32 v169, 0xffff0000, v54
    v_mfma_f32_32x32x16_bf16 v[96:111], a[8:11], a[20:23], v[96:111]
    ds_read_b64_tr_b16 a[32:33], v12 offset:35840
    v_and_b32 v171, 0xffff0000, v55
    v_fma_f32 v164, v164, v138, v142
    v_fma_f32 v166, v166, v138, v142
    v_fma_f32 v168, v168, v138, v142
    ds_read_b64_tr_b16 a[34:35], v12 offset:36096
    v_fma_f32 v170, v170, v138, v142
    v_fma_f32 v165, v165, v138, v142
    v_fma_f32 v167, v167, v138, v142
    v_mfma_f32_32x32x16_bf16 v[112:127], a[8:11], a[24:27], v[112:127]
    ds_read_b64_tr_b16 a[36:37], v13 offset:3072
    v_fma_f32 v169, v169, v138, v142
    v_fma_f32 v171, v171, v138, v142
    v_cvt_pk_bf16_f32 v52, v164, v165
    v_cvt_pk_bf16_f32 v53, v166, v167
    ds_read_b64_tr_b16 a[38:39], v13 offset:3328
    v_cvt_pk_bf16_f32 v54, v168, v169
    v_cvt_pk_bf16_f32 v55, v170, v171
    ds_write_b128 v130, v[52:55]
    s_waitcnt lgkmcnt(1)
    s_waitcnt vmcnt(3)
    s_barrier
    v_mfma_f32_32x32x16_bf16 v[80:95], a[28:31], a[12:15], v[80:95]
    ds_read_b64_tr_b16 a[16:17], v12 offset:8192
    v_lshlrev_b32 v164, 16, v68
    v_lshlrev_b32 v166, 16, v69
    v_lshlrev_b32 v168, 16, v70
    v_lshlrev_b32 v170, 16, v71
    ds_read_b64_tr_b16 a[18:19], v12 offset:8448
    v_and_b32 v165, 0xffff0000, v68
    v_and_b32 v167, 0xffff0000, v69
    v_and_b32 v169, 0xffff0000, v70
    v_mfma_f32_32x32x16_bf16 v[96:111], a[12:15], a[32:35], v[96:111]
    ds_read_b64_tr_b16 a[20:21], v12 offset:40960
    v_and_b32 v171, 0xffff0000, v71
    v_fma_f32 v164, v164, v139, v143
    v_fma_f32 v166, v166, v139, v143
    v_fma_f32 v168, v168, v139, v143
    ds_read_b64_tr_b16 a[22:23], v12 offset:41216
    v_fma_f32 v170, v170, v139, v143
    v_fma_f32 v165, v165, v139, v143
    v_fma_f32 v167, v167, v139, v143
    v_mfma_f32_32x32x16_bf16 v[112:127], a[12:15], a[36:39], v[112:127]
    ds_read_b64_tr_b16 a[24:25], v13 offset:8192
    v_fma_f32 v169, v169, v139, v143
    v_fma_f32 v171, v171, v139, v143
    v_cvt_pk_bf16_f32 v68, v164, v165
    v_cvt_pk_bf16_f32 v69, v166, v167
    ds_read_b64_tr_b16 a[26:27], v13 offset:8448
    v_cvt_pk_bf16_f32 v70, v168, v169
    v_cvt_pk_bf16_f32 v71, v170, v171
    ds_write_b128 v131, v[68:71]
    ds_read_b128 a[0:3], v132
    ds_read_b128 a[4:7], v133
    ds_read_b128 a[8:11], v134
    ds_read_b128 a[12:15], v135
    s_waitcnt lgkmcnt(0)
    v_mfma_f32_32x32x16_bf16 v[80:95], a[16:19], a[0:3], v[80:95]
    ds_read_b64_tr_b16 a[28:29], v12 offset:9216
    v_lshlrev_b32 v164, 16, v24
    v_lshlrev_b32 v166, 16, v25
    v_lshlrev_b32 v168, 16, v26
    v_lshlrev_b32 v170, 16, v27
    v_and_b32 v165, 0xffff0000, v24
    v_and_b32 v167, 0xffff0000, v25
    ds_read_b64_tr_b16 a[30:31], v12 offset:9472
    v_and_b32 v169, 0xffff0000, v26
    v_and_b32 v171, 0xffff0000, v27
    v_fma_f32 v164, v164, v136, v140
    v_fma_f32 v166, v166, v136, v140
    v_fma_f32 v168, v168, v136, v140
    v_mfma_f32_32x32x16_bf16 v[96:111], a[0:3], a[20:23], v[96:111]
    ds_read_b64_tr_b16 a[32:33], v12 offset:41984
    v_fma_f32 v170, v170, v136, v140
    v_fma_f32 v165, v165, v136, v140
    v_fma_f32 v167, v167, v136, v140
    v_fma_f32 v169, v169, v136, v140
    v_fma_f32 v171, v171, v136, v140
    v_cvt_pk_bf16_f32 v24, v164, v165
    ds_read_b64_tr_b16 a[34:35], v12 offset:42240
    v_cvt_pk_bf16_f32 v25, v166, v167
    v_cvt_pk_bf16_f32 v26, v168, v169
    v_cvt_pk_bf16_f32 v27, v170, v171
    ds_write_b128 v128, v[24:27]
    s_mov_b32 s31, 1179648
    v_mfma_f32_32x32x16_bf16 v[112:127], a[0:3], a[24:27], v[112:127]
    ds_read_b64_tr_b16 a[36:37], v13 offset:9216
    s_add_u32 m0, s30, 24576
    s_nop 0
    buffer_load_dwordx4 v10, s[16:19], s31 offen lds
    s_mov_b32 s31, 1180672
    s_add_u32 m0, s30, 57344
    s_nop 0
    ds_read_b64_tr_b16 a[38:39], v13 offset:9472
    buffer_load_dwordx4 v10, s[16:19], s31 offen lds
    s_mov_b32 s31, 1181696
    s_add_u32 m0, s30, 90112
    s_nop 0
    buffer_load_dwordx4 v10, s[16:19], s31 offen lds
    s_waitcnt lgkmcnt(0)
    v_mfma_f32_32x32x16_bf16 v[80:95], a[28:31], a[4:7], v[80:95]
    ds_read_b64_tr_b16 a[16:17], v12 offset:10240
    v_lshlrev_b32 v164, 16, v40
    v_lshlrev_b32 v166, 16, v41
    v_lshlrev_b32 v168, 16, v42
    v_lshlrev_b32 v170, 16, v43
    ds_read_b64_tr_b16 a[18:19], v12 offset:10496
    v_and_b32 v165, 0xffff0000, v40
    v_and_b32 v167, 0xffff0000, v41
    v_and_b32 v169, 0xffff0000, v42
    v_mfma_f32_32x32x16_bf16 v[96:111], a[4:7], a[32:35], v[96:111]
    ds_read_b64_tr_b16 a[20:21], v12 offset:43008
    v_and_b32 v171, 0xffff0000, v43
    v_fma_f32 v164, v164, v137, v141
    v_fma_f32 v166, v166, v137, v141
    v_fma_f32 v168, v168, v137, v141
    ds_read_b64_tr_b16 a[22:23], v12 offset:43264
    v_fma_f32 v170, v170, v137, v141
    v_fma_f32 v165, v165, v137, v141
    v_fma_f32 v167, v167, v137, v141
    v_mfma_f32_32x32x16_bf16 v[112:127], a[4:7], a[36:39], v[112:127]
    ds_read_b64_tr_b16 a[24:25], v13 offset:10240
    v_fma_f32 v169, v169, v137, v141
    v_fma_f32 v171, v171, v137, v141
    v_cvt_pk_bf16_f32 v40, v164, v165
    v_cvt_pk_bf16_f32 v41, v166, v167
    ds_read_b64_tr_b16 a[26:27], v13 offset:10496
    v_cvt_pk_bf16_f32 v42, v168, v169
    v_cvt_pk_bf16_f32 v43, v170, v171
    ds_write_b128 v129, v[40:43]
    s_waitcnt lgkmcnt(1)
    v_mfma_f32_32x32x16_bf16 v[80:95], a[16:19], a[8:11], v[80:95]
    ds_read_b64_tr_b16 a[28:29], v12 offset:11264
    v_lshlrev_b32 v164, 16, v56
    v_lshlrev_b32 v166, 16, v57
    v_lshlrev_b32 v168, 16, v58
    v_lshlrev_b32 v170, 16, v59
    ds_read_b64_tr_b16 a[30:31], v12 offset:11520
    v_and_b32 v165, 0xffff0000, v56
    v_and_b32 v167, 0xffff0000, v57
    v_and_b32 v169, 0xffff0000, v58
    v_mfma_f32_32x32x16_bf16 v[96:111], a[8:11], a[20:23], v[96:111]
    ds_read_b64_tr_b16 a[32:33], v12 offset:44032
    v_and_b32 v171, 0xffff0000, v59
    v_fma_f32 v164, v164, v138, v142
    v_fma_f32 v166, v166, v138, v142
    v_fma_f32 v168, v168, v138, v142
    ds_read_b64_tr_b16 a[34:35], v12 offset:44288
    v_fma_f32 v170, v170, v138, v142
    v_fma_f32 v165, v165, v138, v142
    v_fma_f32 v167, v167, v138, v142
    v_mfma_f32_32x32x16_bf16 v[112:127], a[8:11], a[24:27], v[112:127]
    ds_read_b64_tr_b16 a[36:37], v13 offset:11264
    v_fma_f32 v169, v169, v138, v142
    v_fma_f32 v171, v171, v138, v142
    v_cvt_pk_bf16_f32 v56, v164, v165
    v_cvt_pk_bf16_f32 v57, v166, v167
    ds_read_b64_tr_b16 a[38:39], v13 offset:11520
    v_cvt_pk_bf16_f32 v58, v168, v169
    v_cvt_pk_bf16_f32 v59, v170, v171
    ds_write_b128 v130, v[56:59]
    s_waitcnt lgkmcnt(1)
    s_waitcnt vmcnt(3)
    s_barrier
    v_mfma_f32_32x32x16_bf16 v[80:95], a[28:31], a[12:15], v[80:95]
    ds_read_b64_tr_b16 a[16:17], v12 offset:16384
    v_lshlrev_b32 v164, 16, v72
    v_lshlrev_b32 v166, 16, v73
    v_lshlrev_b32 v168, 16, v74
    v_lshlrev_b32 v170, 16, v75
    ds_read_b64_tr_b16 a[18:19], v12 offset:16640
    v_and_b32 v165, 0xffff0000, v72
    v_and_b32 v167, 0xffff0000, v73
    v_and_b32 v169, 0xffff0000, v74
    v_mfma_f32_32x32x16_bf16 v[96:111], a[12:15], a[32:35], v[96:111]
    ds_read_b64_tr_b16 a[20:21], v12 offset:49152
    v_and_b32 v171, 0xffff0000, v75
    v_fma_f32 v164, v164, v139, v143
    v_fma_f32 v166, v166, v139, v143
    v_fma_f32 v168, v168, v139, v143
    ds_read_b64_tr_b16 a[22:23], v12 offset:49408
    v_fma_f32 v170, v170, v139, v143
    v_fma_f32 v165, v165, v139, v143
    v_fma_f32 v167, v167, v139, v143
    v_mfma_f32_32x32x16_bf16 v[112:127], a[12:15], a[36:39], v[112:127]
    ds_read_b64_tr_b16 a[24:25], v13 offset:16384
    v_fma_f32 v169, v169, v139, v143
    v_fma_f32 v171, v171, v139, v143
    v_cvt_pk_bf16_f32 v72, v164, v165
    v_cvt_pk_bf16_f32 v73, v166, v167
    ds_read_b64_tr_b16 a[26:27], v13 offset:16640
    v_cvt_pk_bf16_f32 v74, v168, v169
    v_cvt_pk_bf16_f32 v75, v170, v171
    ds_write_b128 v131, v[72:75]
    ds_read_b128 a[0:3], v132
    ds_read_b128 a[4:7], v133
    ds_read_b128 a[8:11], v134
    ds_read_b128 a[12:15], v135
    s_waitcnt lgkmcnt(0)
    v_mfma_f32_32x32x16_bf16 v[80:95], a[16:19], a[0:3], v[80:95]
    ds_read_b64_tr_b16 a[28:29], v12 offset:17408
    v_lshlrev_b32 v164, 16, v28
    v_lshlrev_b32 v166, 16, v29
    v_lshlrev_b32 v168, 16, v30
    v_lshlrev_b32 v170, 16, v31
    ds_read_b64_tr_b16 a[30:31], v12 offset:17664
    v_and_b32 v165, 0xffff0000, v28
    v_and_b32 v167, 0xffff0000, v29
    v_and_b32 v169, 0xffff0000, v30
    v_mfma_f32_32x32x16_bf16 v[96:111], a[0:3], a[20:23], v[96:111]
    ds_read_b64_tr_b16 a[32:33], v12 offset:50176
    v_and_b32 v171, 0xffff0000, v31
    v_fma_f32 v164, v164, v136, v140
    v_fma_f32 v166, v166, v136, v140
    v_fma_f32 v168, v168, v136, v140
    ds_read_b64_tr_b16 a[34:35], v12 offset:50432
    v_fma_f32 v170, v170, v136, v140
    v_fma_f32 v165, v165, v136, v140
    v_fma_f32 v167, v167, v136, v140
    v_mfma_f32_32x32x16_bf16 v[112:127], a[0:3], a[24:27], v[112:127]
    ds_read_b64_tr_b16 a[36:37], v13 offset:17408
    v_fma_f32 v169, v169, v136, v140
    v_fma_f32 v171, v171, v136, v140
    v_cvt_pk_bf16_f32 v28, v164, v165
    v_cvt_pk_bf16_f32 v29, v166, v167
    ds_read_b64_tr_b16 a[38:39], v13 offset:17664
    v_cvt_pk_bf16_f32 v30, v168, v169
    v_cvt_pk_bf16_f32 v31, v170, v171
    ds_write_b128 v128, v[28:31]
    s_waitcnt lgkmcnt(1)
    v_mfma_f32_32x32x16_bf16 v[80:95], a[28:31], a[4:7], v[80:95]
    ds_read_b64_tr_b16 a[16:17], v12 offset:18432
    v_lshlrev_b32 v164, 16, v44
    v_lshlrev_b32 v166, 16, v45
    v_lshlrev_b32 v168, 16, v46
    v_lshlrev_b32 v170, 16, v47
    ds_read_b64_tr_b16 a[18:19], v12 offset:18688
    v_and_b32 v165, 0xffff0000, v44
    v_and_b32 v167, 0xffff0000, v45
    v_and_b32 v169, 0xffff0000, v46
    v_mfma_f32_32x32x16_bf16 v[96:111], a[4:7], a[32:35], v[96:111]
    ds_read_b64_tr_b16 a[20:21], v12 offset:51200
    v_and_b32 v171, 0xffff0000, v47
    v_fma_f32 v164, v164, v137, v141
    v_fma_f32 v166, v166, v137, v141
    v_fma_f32 v168, v168, v137, v141
    ds_read_b64_tr_b16 a[22:23], v12 offset:51456
    v_fma_f32 v170, v170, v137, v141
    v_fma_f32 v165, v165, v137, v141
    v_fma_f32 v167, v167, v137, v141
    v_mfma_f32_32x32x16_bf16 v[112:127], a[4:7], a[36:39], v[112:127]
    ds_read_b64_tr_b16 a[24:25], v13 offset:18432
    v_fma_f32 v169, v169, v137, v141
    v_fma_f32 v171, v171, v137, v141
    v_cvt_pk_bf16_f32 v44, v164, v165
    v_cvt_pk_bf16_f32 v45, v166, v167
    ds_read_b64_tr_b16 a[26:27], v13 offset:18688
    v_cvt_pk_bf16_f32 v46, v168, v169
    v_cvt_pk_bf16_f32 v47, v170, v171
    ds_write_b128 v129, v[44:47]
    s_waitcnt lgkmcnt(1)
    v_mfma_f32_32x32x16_bf16 v[80:95], a[16:19], a[8:11], v[80:95]
    ds_read_b64_tr_b16 a[28:29], v12 offset:19456
    v_lshlrev_b32 v164, 16, v60
    v_lshlrev_b32 v166, 16, v61
    v_lshlrev_b32 v168, 16, v62
    v_lshlrev_b32 v170, 16, v63
    ds_read_b64_tr_b16 a[30:31], v12 offset:19712
    v_and_b32 v165, 0xffff0000, v60
    v_and_b32 v167, 0xffff0000, v61
    v_and_b32 v169, 0xffff0000, v62
    v_mfma_f32_32x32x16_bf16 v[96:111], a[8:11], a[20:23], v[96:111]
    ds_read_b64_tr_b16 a[32:33], v12 offset:52224
    v_and_b32 v171, 0xffff0000, v63
    v_fma_f32 v164, v164, v138, v142
    v_fma_f32 v166, v166, v138, v142
    v_fma_f32 v168, v168, v138, v142
    ds_read_b64_tr_b16 a[34:35], v12 offset:52480
    v_fma_f32 v170, v170, v138, v142
    v_fma_f32 v165, v165, v138, v142
    v_fma_f32 v167, v167, v138, v142
    v_mfma_f32_32x32x16_bf16 v[112:127], a[8:11], a[24:27], v[112:127]
    ds_read_b64_tr_b16 a[36:37], v13 offset:19456
    v_fma_f32 v169, v169, v138, v142
    v_fma_f32 v171, v171, v138, v142
    v_cvt_pk_bf16_f32 v60, v164, v165
    v_cvt_pk_bf16_f32 v61, v166, v167
    ds_read_b64_tr_b16 a[38:39], v13 offset:19712
    v_cvt_pk_bf16_f32 v62, v168, v169
    v_cvt_pk_bf16_f32 v63, v170, v171
    ds_write_b128 v130, v[60:63]
    s_waitcnt lgkmcnt(1)
    s_waitcnt vmcnt(0)
    s_barrier
    v_mfma_f32_32x32x16_bf16 v[80:95], a[28:31], a[12:15], v[80:95]
    ds_read_b64_tr_b16 a[16:17], v12 offset:24576
    v_lshlrev_b32 v164, 16, v76
    v_lshlrev_b32 v166, 16, v77
    v_lshlrev_b32 v168, 16, v78
    v_lshlrev_b32 v170, 16, v79
    ds_read_b64_tr_b16 a[18:19], v12 offset:24832
    v_and_b32 v165, 0xffff0000, v76
    v_and_b32 v167, 0xffff0000, v77
    v_and_b32 v169, 0xffff0000, v78
    v_mfma_f32_32x32x16_bf16 v[96:111], a[12:15], a[32:35], v[96:111]
    ds_read_b64_tr_b16 a[20:21], v12 offset:57344
    v_and_b32 v171, 0xffff0000, v79
    v_fma_f32 v164, v164, v139, v143
    v_fma_f32 v166, v166, v139, v143
    v_fma_f32 v168, v168, v139, v143
    ds_read_b64_tr_b16 a[22:23], v12 offset:57600
    v_fma_f32 v170, v170, v139, v143
    v_fma_f32 v165, v165, v139, v143
    v_fma_f32 v167, v167, v139, v143
    v_mfma_f32_32x32x16_bf16 v[112:127], a[12:15], a[36:39], v[112:127]
    ds_read_b64_tr_b16 a[24:25], v13 offset:24576
    v_fma_f32 v169, v169, v139, v143
    v_fma_f32 v171, v171, v139, v143
    v_cvt_pk_bf16_f32 v76, v164, v165
    v_cvt_pk_bf16_f32 v77, v166, v167
    ds_read_b64_tr_b16 a[26:27], v13 offset:24832
    v_cvt_pk_bf16_f32 v78, v168, v169
    v_cvt_pk_bf16_f32 v79, v170, v171
    ds_write_b128 v131, v[76:79]
    ds_read_b128 a[0:3], v132
    ds_read_b128 a[4:7], v133
    ds_read_b128 a[8:11], v134
    ds_read_b128 a[12:15], v135
    s_waitcnt lgkmcnt(0)
    v_mfma_f32_32x32x16_bf16 v[80:95], a[16:19], a[0:3], v[80:95]
    ds_read_b64_tr_b16 a[28:29], v12 offset:25600
    ds_read_b64_tr_b16 a[30:31], v12 offset:25856
    v_mfma_f32_32x32x16_bf16 v[96:111], a[0:3], a[20:23], v[96:111]
    ds_read_b64_tr_b16 a[32:33], v12 offset:58368
    ds_read_b64_tr_b16 a[34:35], v12 offset:58624
    v_mfma_f32_32x32x16_bf16 v[112:127], a[0:3], a[24:27], v[112:127]
    ds_read_b64_tr_b16 a[36:37], v13 offset:25600
    ds_read_b64_tr_b16 a[38:39], v13 offset:25856
    s_waitcnt lgkmcnt(0)
    v_mfma_f32_32x32x16_bf16 v[80:95], a[28:31], a[4:7], v[80:95]
    ds_read_b64_tr_b16 a[16:17], v12 offset:26624
    ds_read_b64_tr_b16 a[18:19], v12 offset:26880
    v_mfma_f32_32x32x16_bf16 v[96:111], a[4:7], a[32:35], v[96:111]
    ds_read_b64_tr_b16 a[20:21], v12 offset:59392
    ds_read_b64_tr_b16 a[22:23], v12 offset:59648
    v_mfma_f32_32x32x16_bf16 v[112:127], a[4:7], a[36:39], v[112:127]
    ds_read_b64_tr_b16 a[24:25], v13 offset:26624
    ds_read_b64_tr_b16 a[26:27], v13 offset:26880
    s_waitcnt lgkmcnt(0)
    v_mfma_f32_32x32x16_bf16 v[80:95], a[16:19], a[8:11], v[80:95]
    ds_read_b64_tr_b16 a[28:29], v12 offset:27648
    ds_read_b64_tr_b16 a[30:31], v12 offset:27904
    v_mfma_f32_32x32x16_bf16 v[96:111], a[8:11], a[20:23], v[96:111]
    ds_read_b64_tr_b16 a[32:33], v12 offset:60416
    ds_read_b64_tr_b16 a[34:35], v12 offset:60672
    v_mfma_f32_32x32x16_bf16 v[112:127], a[8:11], a[24:27], v[112:127]
    ds_read_b64_tr_b16 a[36:37], v13 offset:27648
    ds_read_b64_tr_b16 a[38:39], v13 offset:27904
    s_waitcnt lgkmcnt(0)
    v_mfma_f32_32x32x16_bf16 v[80:95], a[28:31], a[12:15], v[80:95]
    v_mfma_f32_32x32x16_bf16 v[96:111], a[12:15], a[32:35], v[96:111]
    v_mfma_f32_32x32x16_bf16 v[112:127], a[12:15], a[36:39], v[112:127]
    s_lshl_b32 s28, s2, 11
    v_lshlrev_b32 v14, 2, v0
    v_add_u32 v14, s28, v14
    buffer_load_dword v13, v14, s[44:47], 0 offen
    s_mul_i32 s28, s2, 5504
    v_lshlrev_b32 v14, 4, v0
    v_add_u32 v14, s28, v14
    buffer_load_dwordx4 a[16:19], v14, s[48:51], 0 offen
    buffer_load_dwordx4 a[20:23], v14, s[52:55], 0 offen
    s_nop 7
    s_nop 7
    s_barrier
    s_lshl_b32 s28, s24, 13
    v_lshlrev_b32 v14, 4, v1
    v_add_u32 v14, s28, v14
    s_xor_b32 s28, s28, 0x8000
    v_lshlrev_b32 v15, 4, v1
    v_add_u32 v15, s28, v15
    s_cmp_eq_u32 s35, 0
    s_cbranch_scc0 K1_KP1
    ds_write_b128 v14, v[80:83] offset:0
    ds_write_b128 v14, v[84:87] offset:1024
    ds_write_b128 v14, v[88:91] offset:2048
    ds_write_b128 v14, v[92:95] offset:3072
    s_waitcnt lgkmcnt(0)
    s_barrier
    ds_read_b128 v[16:19], v15 offset:0
    ds_read_b128 v[20:23], v15 offset:1024
    ds_read_b128 v[24:27], v15 offset:2048
    ds_read_b128 v[28:31], v15 offset:3072
    ds_read_b128 v[32:35], v15 offset:4096
    ds_read_b128 v[36:39], v15 offset:5120
    ds_read_b128 v[40:43], v15 offset:6144
    ds_read_b128 v[44:47], v15 offset:7168
    s_waitcnt lgkmcnt(0)
    v_add_f32 v96, v96, v16
    v_add_f32 v97, v97, v17
    v_add_f32 v98, v98, v18
    v_add_f32 v99, v99, v19
    v_add_f32 v100, v100, v20
    v_add_f32 v101, v101, v21
    v_add_f32 v102, v102, v22
    v_add_f32 v103, v103, v23
    v_add_f32 v104, v104, v24
    v_add_f32 v105, v105, v25
    v_add_f32 v106, v106, v26
    v_add_f32 v107, v107, v27
    v_add_f32 v108, v108, v28
    v_add_f32 v109, v109, v29
    v_add_f32 v110, v110, v30
    v_add_f32 v111, v111, v31
    v_add_f32 v112, v112, v32
    v_add_f32 v113, v113, v33
    v_add_f32 v114, v114, v34
    v_add_f32 v115, v115, v35
    v_add_f32 v116, v116, v36
    v_add_f32 v117, v117, v37
    v_add_f32 v118, v118, v38
    v_add_f32 v119, v119, v39
    v_add_f32 v120, v120, v40
    v_add_f32 v121, v121, v41
    v_add_f32 v122, v122, v42
    v_add_f32 v123, v123, v43
    v_add_f32 v124, v124, v44
    v_add_f32 v125, v125, v45
    v_add_f32 v126, v126, v46
    v_add_f32 v127, v127, v47
    v_mul_f32 v144, 0x3fb8aa3b, v96
    v_mul_f32 v145, 0x3fb8aa3b, v97
    v_mul_f32 v146, 0x3fb8aa3b, v98
    v_mul_f32 v147, 0x3fb8aa3b, v99
    v_mul_f32 v148, 0x3fb8aa3b, v100
    v_mul_f32 v149, 0x3fb8aa3b, v101
    v_mul_f32 v150, 0x3fb8aa3b, v102
    v_mul_f32 v151, 0x3fb8aa3b, v103
    v_mul_f32 v152, 0x3fb8aa3b, v104
    v_mul_f32 v153, 0x3fb8aa3b, v105
    v_mul_f32 v154, 0x3fb8aa3b, v106
    v_mul_f32 v155, 0x3fb8aa3b, v107
    v_mul_f32 v156, 0x3fb8aa3b, v108
    v_mul_f32 v157, 0x3fb8aa3b, v109
    v_mul_f32 v158, 0x3fb8aa3b, v110
    v_mul_f32 v159, 0x3fb8aa3b, v111
    v_min_f32 v144, 0, v144
    v_min_f32 v145, 0, v145
    v_min_f32 v146, 0, v146
    v_min_f32 v147, 0, v147
    v_min_f32 v148, 0, v148
    v_min_f32 v149, 0, v149
    v_min_f32 v150, 0, v150
    v_min_f32 v151, 0, v151
    v_min_f32 v152, 0, v152
    v_min_f32 v153, 0, v153
    v_min_f32 v154, 0, v154
    v_min_f32 v155, 0, v155
    v_min_f32 v156, 0, v156
    v_min_f32 v157, 0, v157
    v_min_f32 v158, 0, v158
    v_min_f32 v159, 0, v159
    v_exp_f32 v144, v144
    v_exp_f32 v145, v145
    v_exp_f32 v146, v146
    v_exp_f32 v147, v147
    v_exp_f32 v148, v148
    v_exp_f32 v149, v149
    v_exp_f32 v150, v150
    v_exp_f32 v151, v151
    v_exp_f32 v152, v152
    v_exp_f32 v153, v153
    v_exp_f32 v154, v154
    v_exp_f32 v155, v155
    v_exp_f32 v156, v156
    v_exp_f32 v157, v157
    v_exp_f32 v158, v158
    v_exp_f32 v159, v159
    v_max_f32 v96, 0, v96
    v_max_f32 v97, 0, v97
    v_max_f32 v98, 0, v98
    v_max_f32 v99, 0, v99
    v_max_f32 v100, 0, v100
    v_max_f32 v101, 0, v101
    v_max_f32 v102, 0, v102
    v_max_f32 v103, 0, v103
    v_max_f32 v104, 0, v104
    v_max_f32 v105, 0, v105
    v_max_f32 v106, 0, v106
    v_max_f32 v107, 0, v107
    v_max_f32 v108, 0, v108
    v_max_f32 v109, 0, v109
    v_max_f32 v110, 0, v110
    v_max_f32 v111, 0, v111
    v_add_f32 v144, 0x358637bd, v144
    v_add_f32 v145, 0x358637bd, v145
    v_add_f32 v146, 0x358637bd, v146
    v_add_f32 v147, 0x358637bd, v147
    v_add_f32 v148, 0x358637bd, v148
    v_add_f32 v149, 0x358637bd, v149
    v_add_f32 v150, 0x358637bd, v150
    v_add_f32 v151, 0x358637bd, v151
    v_add_f32 v152, 0x358637bd, v152
    v_add_f32 v153, 0x358637bd, v153
    v_add_f32 v154, 0x358637bd, v154
    v_add_f32 v155, 0x358637bd, v155
    v_add_f32 v156, 0x358637bd, v156
    v_add_f32 v157, 0x358637bd, v157
    v_add_f32 v158, 0x358637bd, v158
    v_add_f32 v159, 0x358637bd, v159
    v_add_f32 v96, v96, v144
    v_add_f32 v97, v97, v145
    v_add_f32 v98, v98, v146
    v_add_f32 v99, v99, v147
    v_add_f32 v100, v100, v148
    v_add_f32 v101, v101, v149
    v_add_f32 v102, v102, v150
    v_add_f32 v103, v103, v151
    v_add_f32 v104, v104, v152
    v_add_f32 v105, v105, v153
    v_add_f32 v106, v106, v154
    v_add_f32 v107, v107, v155
    v_add_f32 v108, v108, v156
    v_add_f32 v109, v109, v157
    v_add_f32 v110, v110, v158
    v_add_f32 v111, v111, v159
    v_cvt_pk_bf16_f32 v16, v96, v97
    v_cvt_pk_bf16_f32 v24, v112, v113
    v_cvt_pk_bf16_f32 v17, v98, v99
    v_cvt_pk_bf16_f32 v25, v114, v115
    v_cvt_pk_bf16_f32 v18, v100, v101
    v_cvt_pk_bf16_f32 v26, v116, v117
    v_cvt_pk_bf16_f32 v19, v102, v103
    v_cvt_pk_bf16_f32 v27, v118, v119
    v_cvt_pk_bf16_f32 v20, v104, v105
    v_cvt_pk_bf16_f32 v28, v120, v121
    v_cvt_pk_bf16_f32 v21, v106, v107
    v_cvt_pk_bf16_f32 v29, v122, v123
    v_cvt_pk_bf16_f32 v22, v108, v109
    v_cvt_pk_bf16_f32 v30, v124, v125
    v_cvt_pk_bf16_f32 v23, v110, v111
    v_cvt_pk_bf16_f32 v31, v126, v127
    v_mov_b32 v32, 0x3f803f80
    v_mov_b32 v33, 0x3f803f80
    v_mov_b32 v34, 0x3f803f80
    v_mov_b32 v35, 0x3f803f80
    s_nop 1
    v_mfma_f32_32x32x16_bf16 v[80:95], v[16:19], v[24:27], 0
    v_mfma_f32_32x32x16_bf16 v[96:111], v[16:19], v[32:35], 0
    v_mfma_f32_32x32x16_bf16 v[80:95], v[20:23], v[28:31], v[80:95]
    v_mfma_f32_32x32x16_bf16 v[96:111], v[20:23], v[32:35], v[96:111]
    s_mul_i32 s29, s34, 2304
    s_add_u32 s29, s29, 98304
    v_and_b32 v5, 15, v1
    v_lshlrev_b32 v5, 2, v5
    v_lshl_add_u32 v5, v7, 10, v5
    v_lshl_add_u32 v5, v3, 8, v5
    v_add_u32 v5, s29, v5
    v_cmp_ne_u32 vcc, 0, v7
    s_nop 7
    s_nop 7
    v_cndmask_b32 v144, v80, v88, vcc
    v_cndmask_b32 v145, v81, v89, vcc
    v_cndmask_b32 v146, v82, v90, vcc
    v_cndmask_b32 v147, v83, v91, vcc
    v_cndmask_b32 v148, v84, v92, vcc
    v_cndmask_b32 v149, v85, v93, vcc
    v_cndmask_b32 v150, v86, v94, vcc
    v_cndmask_b32 v151, v87, v95, vcc
    ds_write_b32 v5, v144 offset:0
    ds_write_b32 v5, v145 offset:64
    ds_write_b32 v5, v146 offset:128
    ds_write_b32 v5, v147 offset:192
    ds_write_b32 v5, v148 offset:512
    ds_write_b32 v5, v149 offset:576
    ds_write_b32 v5, v150 offset:640
    ds_write_b32 v5, v151 offset:704
    v_lshlrev_b32 v6, 4, v3
    v_add_u32 v6, s29, v6
    v_add_u32 v6, 2048, v6
    s_mov_b32 s40, 1
    s_mov_b32 s41, 1
    s_mov_b64 exec, s[40:41]
    ds_write_b32 v6, v96 offset:0
    ds_write_b32 v6, v97 offset:4
    ds_write_b32 v6, v98 offset:8
    ds_write_b32 v6, v99 offset:12
    ds_write_b32 v6, v100 offset:32
    ds_write_b32 v6, v101 offset:36
    ds_write_b32 v6, v102 offset:40
    ds_write_b32 v6, v103 offset:44
    ds_write_b32 v6, v104 offset:64
    ds_write_b32 v6, v105 offset:68
    ds_write_b32 v6, v106 offset:72
    ds_write_b32 v6, v107 offset:76
    ds_write_b32 v6, v108 offset:96
    ds_write_b32 v6, v109 offset:100
    ds_write_b32 v6, v110 offset:104
    ds_write_b32 v6, v111 offset:108
    s_mov_b64 exec, -1
    s_waitcnt lgkmcnt(0)
    s_barrier
    s_branch K1_SUM
K1_KP1:
    ds_write_b128 v14, v[96:99] offset:0
    ds_write_b128 v14, v[100:103] offset:1024
    ds_write_b128 v14, v[104:107] offset:2048
    ds_write_b128 v14, v[108:111] offset:3072
    ds_write_b128 v14, v[112:115] offset:4096
    ds_write_b128 v14, v[116:119] offset:5120
    ds_write_b128 v14, v[120:123] offset:6144
    ds_write_b128 v14, v[124:127] offset:7168
    s_waitcnt lgkmcnt(0)
    s_barrier
    ds_read_b128 v[16:19], v15 offset:0
    ds_read_b128 v[20:23], v15 offset:1024
    ds_read_b128 v[24:27], v15 offset:2048
    ds_read_b128 v[28:31], v15 offset:3072
    s_waitcnt lgkmcnt(0)
    v_add_f32 v80, v80, v16
    v_add_f32 v81, v81, v17
    v_add_f32 v82, v82, v18
    v_add_f32 v83, v83, v19
    v_add_f32 v84, v84, v20
    v_add_f32 v85, v85, v21
    v_add_f32 v86, v86, v22
    v_add_f32 v87, v87, v23
    v_add_f32 v88, v88, v24
    v_add_f32 v89, v89, v25
    v_add_f32 v90, v90, v26
    v_add_f32 v91, v91, v27
    v_add_f32 v92, v92, v28
    v_add_f32 v93, v93, v29
    v_add_f32 v94, v94, v30
    v_add_f32 v95, v95, v31
    v_mul_f32 v144, 0x3fb8aa3b, v80
    v_mul_f32 v145, 0x3fb8aa3b, v81
    v_mul_f32 v146, 0x3fb8aa3b, v82
    v_mul_f32 v147, 0x3fb8aa3b, v83
    v_mul_f32 v148, 0x3fb8aa3b, v84
    v_mul_f32 v149, 0x3fb8aa3b, v85
    v_mul_f32 v150, 0x3fb8aa3b, v86
    v_mul_f32 v151, 0x3fb8aa3b, v87
    v_mul_f32 v152, 0x3fb8aa3b, v88
    v_mul_f32 v153, 0x3fb8aa3b, v89
    v_mul_f32 v154, 0x3fb8aa3b, v90
    v_mul_f32 v155, 0x3fb8aa3b, v91
    v_mul_f32 v156, 0x3fb8aa3b, v92
    v_mul_f32 v157, 0x3fb8aa3b, v93
    v_mul_f32 v158, 0x3fb8aa3b, v94
    v_mul_f32 v159, 0x3fb8aa3b, v95
    v_min_f32 v144, 0, v144
    v_min_f32 v145, 0, v145
    v_min_f32 v146, 0, v146
    v_min_f32 v147, 0, v147
    v_min_f32 v148, 0, v148
    v_min_f32 v149, 0, v149
    v_min_f32 v150, 0, v150
    v_min_f32 v151, 0, v151
    v_min_f32 v152, 0, v152
    v_min_f32 v153, 0, v153
    v_min_f32 v154, 0, v154
    v_min_f32 v155, 0, v155
    v_min_f32 v156, 0, v156
    v_min_f32 v157, 0, v157
    v_min_f32 v158, 0, v158
    v_min_f32 v159, 0, v159
    v_exp_f32 v144, v144
    v_exp_f32 v145, v145
    v_exp_f32 v146, v146
    v_exp_f32 v147, v147
    v_exp_f32 v148, v148
    v_exp_f32 v149, v149
    v_exp_f32 v150, v150
    v_exp_f32 v151, v151
    v_exp_f32 v152, v152
    v_exp_f32 v153, v153
    v_exp_f32 v154, v154
    v_exp_f32 v155, v155
    v_exp_f32 v156, v156
    v_exp_f32 v157, v157
    v_exp_f32 v158, v158
    v_exp_f32 v159, v159
    v_max_f32 v80, 0, v80
    v_max_f32 v81, 0, v81
    v_max_f32 v82, 0, v82
    v_max_f32 v83, 0, v83
    v_max_f32 v84, 0, v84
    v_max_f32 v85, 0, v85
    v_max_f32 v86, 0, v86
    v_max_f32 v87, 0, v87
    v_max_f32 v88, 0, v88
    v_max_f32 v89, 0, v89
    v_max_f32 v90, 0, v90
    v_max_f32 v91, 0, v91
    v_max_f32 v92, 0, v92
    v_max_f32 v93, 0, v93
    v_max_f32 v94, 0, v94
    v_max_f32 v95, 0, v95
    v_add_f32 v144, 0x358637bd, v144
    v_add_f32 v145, 0x358637bd, v145
    v_add_f32 v146, 0x358637bd, v146
    v_add_f32 v147, 0x358637bd, v147
    v_add_f32 v148, 0x358637bd, v148
    v_add_f32 v149, 0x358637bd, v149
    v_add_f32 v150, 0x358637bd, v150
    v_add_f32 v151, 0x358637bd, v151
    v_add_f32 v152, 0x358637bd, v152
    v_add_f32 v153, 0x358637bd, v153
    v_add_f32 v154, 0x358637bd, v154
    v_add_f32 v155, 0x358637bd, v155
    v_add_f32 v156, 0x358637bd, v156
    v_add_f32 v157, 0x358637bd, v157
    v_add_f32 v158, 0x358637bd, v158
    v_add_f32 v159, 0x358637bd, v159
    v_add_f32 v80, v80, v144
    v_add_f32 v81, v81, v145
    v_add_f32 v82, v82, v146
    v_add_f32 v83, v83, v147
    v_add_f32 v84, v84, v148
    v_add_f32 v85, v85, v149
    v_add_f32 v86, v86, v150
    v_add_f32 v87, v87, v151
    v_add_f32 v88, v88, v152
    v_add_f32 v89, v89, v153
    v_add_f32 v90, v90, v154
    v_add_f32 v91, v91, v155
    v_add_f32 v92, v92, v156
    v_add_f32 v93, v93, v157
    v_add_f32 v94, v94, v158
    v_add_f32 v95, v95, v159
    s_lshl_b32 s27, s25, 2
    s_add_u32 s27, s27, s34
    s_lshl_b32 s27, s27, 15
    s_lshl_b32 s29, s26, 11
    s_add_u32 s27, s27, s29
    v_lshlrev_b32 v9, 4, v1
    v_add_u32 v9, s27, v9
    v_cvt_pk_bf16_f32 v144, v80, v81
    v_cvt_pk_bf16_f32 v145, v82, v83
    v_cvt_pk_bf16_f32 v146, v84, v85
    v_cvt_pk_bf16_f32 v147, v86, v87
    v_cvt_pk_bf16_f32 v148, v88, v89
    v_cvt_pk_bf16_f32 v149, v90, v91
    v_cvt_pk_bf16_f32 v150, v92, v93
    v_cvt_pk_bf16_f32 v151, v94, v95
    buffer_store_dwordx4 v[144:147], v9, s[20:23], 0 offen offset:0
    buffer_store_dwordx4 v[148:151], v9, s[20:23], 0 offen offset:1024
    s_barrier
K1_SUM:
    v_lshlrev_b32 v5, 2, v0
    v_add_u32 v5, 98304, v5
    ds_read_b32 v160, v5 offset:0
    ds_read_b32 v161, v5 offset:2304
    ds_read_b32 v162, v5 offset:4608
    ds_read_b32 v163, v5 offset:6912
    v_cmp_gt_u32 vcc, 32, v0
    s_and_saveexec_b64 s[40:41], vcc
    ds_read_b32 v164, v5 offset:2048
    ds_read_b32 v165, v5 offset:4352
    ds_read_b32 v166, v5 offset:6656
    ds_read_b32 v167, v5 offset:8960
    s_mov_b64 exec, s[40:41]
    s_lshl_b32 s29, s25, 5
    s_lshl_b32 s30, s26, 1
    s_add_u32 s29, s29, s30
    s_mul_i32 s29, s29, 1088
    s_add_u32 s29, s29, 0x200000
    v_lshrrev_b32 v6, 8, v0
    v_lshlrev_b32 v6, 6, v6
    v_lshl_add_u32 v6, v0, 2, v6
    v_add_u32 v6, s29, v6
    s_waitcnt lgkmcnt(0)
    v_add_f32 v160, v160, v161
    v_add_f32 v162, v162, v163
    v_add_f32 v160, v160, v162
    buffer_store_dword v160, v6, s[20:23], 0 offen
    v_cmp_gt_u32 vcc, 32, v0
    s_and_saveexec_b64 s[40:41], vcc
    s_cbranch_execz K1_END
    v_add_f32 v164, v164, v165
    v_add_f32 v166, v166, v167
    v_add_f32 v164, v164, v166
    v_lshrrev_b32 v6, 4, v0
    v_mul_u32_u24 v6, 1088, v6
    v_and_b32 v7, 15, v0
    v_lshl_add_u32 v6, v7, 2, v6
    v_add_u32 v6, s29, v6
    buffer_store_dword v164, v6, s[20:23], 0 offen offset:1024
K1_END:
    s_endpgm
.p2align 8
.globl kr_reduce_kernel
.type kr_reduce_kernel,@function
kr_reduce_kernel:
    s_cmp_ge_u32 s2, 32
    s_cbranch_scc1 KR_END
    s_load_dwordx2 s[8:9], s[0:1], 72
    v_lshrrev_b32 v4, 6, v0
    s_nop 0
    v_readfirstlane_b32 s24, v4
    s_waitcnt lgkmcnt(0)
    s_mov_b32 s20, s8
    s_mov_b32 s21, s9
    s_mov_b32 s22, 0xb60000
    s_mov_b32 s23, 0x00020000
    s_mul_i32 s25, s2, 1088
    s_add_u32 s25, s25, 0x200000
    v_lshlrev_b32 v1, 2, v0
    v_add_u32 v1, s25, v1
    s_mov_b32 s26, 0
    buffer_load_dword v16, v1, s[20:23], s26 offen
    s_mov_b32 s26, 34816
    buffer_load_dword v17, v1, s[20:23], s26 offen
    s_mov_b32 s26, 69632
    buffer_load_dword v18, v1, s[20:23], s26 offen
    s_mov_b32 s26, 104448
    buffer_load_dword v19, v1, s[20:23], s26 offen
    s_mov_b32 s26, 139264
    buffer_load_dword v20, v1, s[20:23], s26 offen
    s_mov_b32 s26, 174080
    buffer_load_dword v21, v1, s[20:23], s26 offen
    s_mov_b32 s26, 208896
    buffer_load_dword v22, v1, s[20:23], s26 offen
    s_mov_b32 s26, 243712
    buffer_load_dword v23, v1, s[20:23], s26 offen
    s_mov_b32 s26, 278528
    buffer_load_dword v24, v1, s[20:23], s26 offen
    s_mov_b32 s26, 313344
    buffer_load_dword v25, v1, s[20:23], s26 offen
    s_mov_b32 s26, 348160
    buffer_load_dword v26, v1, s[20:23], s26 offen
    s_mov_b32 s26, 382976
    buffer_load_dword v27, v1, s[20:23], s26 offen
    s_mov_b32 s26, 417792
    buffer_load_dword v28, v1, s[20:23], s26 offen
    s_mov_b32 s26, 452608
    buffer_load_dword v29, v1, s[20:23], s26 offen
    s_mov_b32 s26, 487424
    buffer_load_dword v30, v1, s[20:23], s26 offen
    s_mov_b32 s26, 522240
    buffer_load_dword v31, v1, s[20:23], s26 offen
    v_cmp_gt_u32 vcc, 16, v0
    s_and_saveexec_b64 s[40:41], vcc
    s_mov_b32 s26, 0
    buffer_load_dword v32, v1, s[20:23], s26 offen offset:1024
    s_mov_b32 s26, 34816
    buffer_load_dword v33, v1, s[20:23], s26 offen offset:1024
    s_mov_b32 s26, 69632
    buffer_load_dword v34, v1, s[20:23], s26 offen offset:1024
    s_mov_b32 s26, 104448
    buffer_load_dword v35, v1, s[20:23], s26 offen offset:1024
    s_mov_b32 s26, 139264
    buffer_load_dword v36, v1, s[20:23], s26 offen offset:1024
    s_mov_b32 s26, 174080
    buffer_load_dword v37, v1, s[20:23], s26 offen offset:1024
    s_mov_b32 s26, 208896
    buffer_load_dword v38, v1, s[20:23], s26 offen offset:1024
    s_mov_b32 s26, 243712
    buffer_load_dword v39, v1, s[20:23], s26 offen offset:1024
    s_mov_b32 s26, 278528
    buffer_load_dword v40, v1, s[20:23], s26 offen offset:1024
    s_mov_b32 s26, 313344
    buffer_load_dword v41, v1, s[20:23], s26 offen offset:1024
    s_mov_b32 s26, 348160
    buffer_load_dword v42, v1, s[20:23], s26 offen offset:1024
    s_mov_b32 s26, 382976
    buffer_load_dword v43, v1, s[20:23], s26 offen offset:1024
    s_mov_b32 s26, 417792
    buffer_load_dword v44, v1, s[20:23], s26 offen offset:1024
    s_mov_b32 s26, 452608
    buffer_load_dword v45, v1, s[20:23], s26 offen offset:1024
    s_mov_b32 s26, 487424
    buffer_load_dword v46, v1, s[20:23], s26 offen offset:1024
    s_mov_b32 s26, 522240
    buffer_load_dword v47, v1, s[20:23], s26 offen offset:1024
    s_mov_b64 exec, s[40:41]
    s_waitcnt vmcnt(0)
    v_add_f32 v16, v16, v17
    v_add_f32 v18, v18, v19
    v_add_f32 v20, v20, v21
    v_add_f32 v22, v22, v23
    v_add_f32 v24, v24, v25
    v_add_f32 v26, v26, v27
    v_add_f32 v28, v28, v29
    v_add_f32 v30, v30, v31
    v_add_f32 v16, v16, v18
    v_add_f32 v20, v20, v22
    v_add_f32 v24, v24, v26
    v_add_f32 v28, v28, v30
    v_add_f32 v16, v16, v20
    v_add_f32 v24, v24, v28
    v_add_f32 v16, v16, v24
    v_cvt_pk_bf16_f32 v16, v16, v16
    v_and_b32 v2, 15, v0
    v_lshrrev_b32 v3, 4, v0
    v_lshlrev_b32 v2, 4, v2
    v_bfe_u32 v4, v3, 2, 1
    v_lshl_add_u32 v2, v4, 9, v2
    v_and_b32 v4, 3, v3
    v_lshl_add_u32 v2, v4, 1, v2
    v_lshrrev_b32 v4, 3, v3
    v_lshl_add_u32 v2, v4, 3, v2
    s_lshl_b32 s26, s2, 10
    s_add_u32 s26, s26, 0x300000
    v_add_u32 v2, s26, v2
    buffer_store_short v16, v2, s[20:23], 0 offen
    v_cmp_gt_u32 vcc, 16, v0
    s_and_saveexec_b64 s[40:41], vcc
    s_cbranch_execz KR_END
    v_add_f32 v32, v32, v33
    v_add_f32 v34, v34, v35
    v_add_f32 v36, v36, v37
    v_add_f32 v38, v38, v39
    v_add_f32 v40, v40, v41
    v_add_f32 v42, v42, v43
    v_add_f32 v44, v44, v45
    v_add_f32 v46, v46, v47
    v_add_f32 v32, v32, v34
    v_add_f32 v36, v36, v38
    v_add_f32 v40, v40, v42
    v_add_f32 v44, v44, v46
    v_add_f32 v32, v32, v36
    v_add_f32 v40, v40, v44
    v_add_f32 v32, v32, v40
    v_cvt_pk_bf16_f32 v32, v32, v32
    v_bfe_u32 v4, v0, 2, 1
    v_lshlrev_b32 v2, 9, v4
    v_and_b32 v4, 3, v0
    v_lshl_add_u32 v2, v4, 1, v2
    v_lshrrev_b32 v4, 3, v0
    v_lshl_add_u32 v2, v4, 3, v2
    v_add_u32 v2, s26, v2
    buffer_store_short v32, v2, s[20:23], 0 offen offset:256
    buffer_store_short v32, v2, s[20:23], 0 offen offset:320
KR_END:
    s_endpgm
.p2align 8
.globl k2_attnout_kernel
.type k2_attnout_kernel,@function
k2_attnout_kernel:
    s_cmp_ge_u32 s2, 256
    s_cbranch_scc1 K2_END
    s_load_dwordx2 s[4:5], s[0:1], 0
    s_load_dwordx2 s[6:7], s[0:1], 16
    s_load_dwordx2 s[8:9], s[0:1], 72
    s_load_dwordx4 s[40:43], s[0:1], 32
    s_load_dwordx2 s[10:11], s[0:1], 48
    v_and_b32 v1, 63, v0
    v_lshrrev_b32 v4, 6, v0
    s_nop 0
    v_readfirstlane_b32 s24, v4
    v_and_b32 v2, 31, v1
    v_lshrrev_b32 v3, 5, v1
    s_and_b32 s34, s24, 3
    s_lshr_b32 s35, s24, 2
    s_and_b32 s25, s2, 7
    s_lshl_b32 s25, s25, 1
    s_bfe_u32 s26, s2, 0x10003
    s_or_b32 s25, s25, s26
    s_lshr_b32 s26, s2, 4
    s_waitcnt lgkmcnt(0)
    s_mov_b32 s12, s4
    s_mov_b32 s13, s5
    s_mov_b32 s14, 0x200000
    s_mov_b32 s15, 0x00020000
    s_mov_b32 s16, s6
    s_mov_b32 s17, s7
    s_mov_b32 s18, 0x80000
    s_mov_b32 s19, 0x00020000
    s_mov_b32 s20, s8
    s_mov_b32 s21, s9
    s_mov_b32 s22, 0xb60000
    s_mov_b32 s23, 0x00020000
    s_mov_b32 s44, s40
    s_mov_b32 s45, s41
    s_mov_b32 s46, 0x158000
    s_mov_b32 s47, 0x00020000
    s_mov_b32 s48, s42
    s_mov_b32 s49, s43
    s_mov_b32 s50, 0x158000
    s_mov_b32 s51, 0x00020000
    s_mov_b32 s52, s10
    s_mov_b32 s53, s11
    s_mov_b32 s54, 0x158000
    s_mov_b32 s55, 0x00020000
    v_lshrrev_b32 v10, 2, v1
    s_lshl_b32 s28, s24, 6
    v_add_u32 v10, s28, v10
    v_lshlrev_b32 v10, 10, v10
    v_and_b32 v11, 3, v1
    v_lshl_add_u32 v10, v11, 4, v10
    s_lshl_b32 s29, s26, 6
    v_add_u32 v10, s29, v10
    s_lshl_b32 s30, s24, 12
    s_lshl_b32 s27, s25, 2
    s_add_u32 s27, s27, s34
    s_lshl_b32 s28, s27, 15
    v_lshlrev_b32 v8, 4, v1
    v_add_u32 v8, s28, v8
    s_lshl_b32 s28, s35, 10
    v_add_u32 v9, s28, v8
    v_lshlrev_b32 v11, 4, v1
    s_lshl_b32 s28, s24, 12
    s_add_u32 s28, s28, 0x300000
    v_add_u32 v11, s28, v11
    s_add_u32 m0, s30, 32768
    s_nop 0
    buffer_load_dwordx4 v11, s[20:23], 0 offen offset:0 lds
    s_add_u32 m0, s30, 32768
    s_nop 0
    buffer_load_dwordx4 v11, s[20:23], 0 offen offset:1024 lds
    s_add_u32 m0, s30, 32768
    s_nop 0
    buffer_load_dwordx4 v11, s[20:23], 0 offen offset:2048 lds
    s_add_u32 m0, s30, 32768
    s_nop 0
    buffer_load_dwordx4 v11, s[20:23], 0 offen offset:3072 lds
    buffer_load_dwordx4 v[16:19], v9, s[20:23], 0 offen offset:0
    buffer_load_dwordx4 v[20:23], v9, s[20:23], 0 offen offset:2048
    s_mov_b32 s31, 0
    s_add_u32 m0, s30, 0
    s_nop 0
    buffer_load_dwordx4 v10, s[16:19], s31 offen lds
    s_mov_b32 s31, 16384
    s_add_u32 m0, s30, 1024
    s_nop 0
    buffer_load_dwordx4 v10, s[16:19], s31 offen lds
    s_mov_b32 s31, 32768
    s_add_u32 m0, s30, 2048
    s_nop 0
    buffer_load_dwordx4 v10, s[16:19], s31 offen lds
    s_mov_b32 s31, 49152
    s_add_u32 m0, s30, 3072
    s_nop 0
    buffer_load_dwordx4 v10, s[16:19], s31 offen lds
    v_add_u32 v9, 0x1000, v9
    buffer_load_dwordx4 v[24:27], v9, s[20:23], 0 offen offset:0
    buffer_load_dwordx4 v[28:31], v9, s[20:23], 0 offen offset:2048
    v_add_u32 v9, 0x1000, v9
    buffer_load_dwordx4 v[32:35], v9, s[20:23], 0 offen offset:0
    buffer_load_dwordx4 v[36:39], v9, s[20:23], 0 offen offset:2048
    v_add_u32 v9, 0x1000, v9
    buffer_load_dwordx4 v[40:43], v9, s[20:23], 0 offen offset:0
    buffer_load_dwordx4 v[44:47], v9, s[20:23], 0 offen offset:2048
    v_add_u32 v9, 0x1000, v9
    buffer_load_dwordx4 v[48:51], v9, s[20:23], 0 offen offset:0
    buffer_load_dwordx4 v[52:55], v9, s[20:23], 0 offen offset:2048
    v_add_u32 v9, 0x1000, v9
    buffer_load_dwordx4 v[56:59], v9, s[20:23], 0 offen offset:0
    buffer_load_dwordx4 v[60:63], v9, s[20:23], 0 offen offset:2048
    v_add_u32 v9, 0x1000, v9
    buffer_load_dwordx4 v[64:67], v9, s[20:23], 0 offen offset:0
    buffer_load_dwordx4 v[68:71], v9, s[20:23], 0 offen offset:2048
    v_add_u32 v9, 0x1000, v9
    buffer_load_dwordx4 v[72:75], v9, s[20:23], 0 offen offset:0
    buffer_load_dwordx4 v[76:79], v9, s[20:23], 0 offen offset:2048
    s_lshl_b32 s28, s27, 5
    v_add_u32 v4, s28, v2
    v_lshlrev_b32 v4, 10, v4
    v_lshl_add_u32 v4, v3, 3, v4
    s_lshl_b32 s29, s26, 6
    s_lshl_b32 s28, s35, 5
    s_add_u32 s29, s29, s28
    v_add_u32 v4, s29, v4
    buffer_load_dwordx2 v[144:145], v4, s[12:15], 0 offen offset:0
    buffer_load_dwordx2 v[146:147], v4, s[12:15], 0 offen offset:16
    v_bfe_u32 v5, v1, 2, 2
    v_and_b32 v6, 3, v1
    v_bfe_u32 v7, v1, 4, 1
    v_lshl_add_u32 v12, v3, 2, v5
    v_lshlrev_b32 v12, 6, v12
    v_lshl_add_u32 v12, v7, 5, v12
    v_lshl_add_u32 v12, v6, 3, v12
    s_lshl_b32 s28, s35, 10
    v_add_u32 v12, s28, v12
    v_lshlrev_b32 v13, 4, v1
    s_lshl_b32 s28, s35, 10
    s_add_u32 s28, s28, 32768
    v_add_u32 v13, s28, v13
    s_waitcnt vmcnt(16)
    s_barrier
    ds_read_b128 a[0:3], v13 offset:0
    ds_read_b128 a[4:7], v13 offset:2048
    ds_read_b128 a[8:11], v13 offset:4096
    ds_read_b128 a[12:15], v13 offset:6144
    ds_read_b64_tr_b16 a[16:17], v12 offset:0
    ds_read_b64_tr_b16 a[18:19], v12 offset:512
    ds_read_b64_tr_b16 a[20:21], v12 offset:2048
    ds_read_b64_tr_b16 a[22:23], v12 offset:2560
    s_waitcnt lgkmcnt(7)
    v_mfma_f32_32x32x16_bf16 v[80:95], a[0:3], v[16:19], 0
    s_waitcnt lgkmcnt(6)
    v_mfma_f32_32x32x16_bf16 v[96:111], a[4:7], v[20:23], 0
    s_nop 7
    s_nop 3
    v_add_f32 v152, 0x358637bd, v88
    v_rcp_f32 v152, v152
    s_nop 0
    v_mul_f32 v80, v80, v152
    v_mul_f32 v81, v81, v152
    v_mul_f32 v82, v82, v152
    v_mul_f32 v83, v83, v152
    v_mul_f32 v84, v84, v152
    v_mul_f32 v85, v85, v152
    v_mul_f32 v86, v86, v152
    v_mul_f32 v87, v87, v152
    v_cvt_pk_bf16_f32 v16, v80, v81
    v_cvt_pk_bf16_f32 v17, v82, v83
    v_cvt_pk_bf16_f32 v18, v84, v85
    v_cvt_pk_bf16_f32 v19, v86, v87
    s_waitcnt vmcnt(15)
    s_waitcnt lgkmcnt(5)
    v_mfma_f32_32x32x16_bf16 v[112:127], a[8:11], v[24:27], 0
    ds_read_b128 a[0:3], v13 offset:8192
    ds_read_b64_tr_b16 a[24:25], v12 offset:4096
    ds_read_b64_tr_b16 a[26:27], v12 offset:4608
    v_add_f32 v152, 0x358637bd, v104
    v_rcp_f32 v152, v152
    s_nop 0
    v_mul_f32 v96, v96, v152
    v_mul_f32 v97, v97, v152
    v_mul_f32 v98, v98, v152
    v_mul_f32 v99, v99, v152
    v_mul_f32 v100, v100, v152
    s_waitcnt lgkmcnt(5)
    v_mfma_f32_32x32x16_bf16 v[128:143], a[16:19], v[16:19], 0
    v_mul_f32 v101, v101, v152
    v_mul_f32 v102, v102, v152
    v_mul_f32 v103, v103, v152
    v_cvt_pk_bf16_f32 v20, v96, v97
    v_cvt_pk_bf16_f32 v21, v98, v99
    v_cvt_pk_bf16_f32 v22, v100, v101
    v_cvt_pk_bf16_f32 v23, v102, v103
    s_waitcnt vmcnt(14)
    v_mfma_f32_32x32x16_bf16 v[80:95], a[12:15], v[28:31], 0
    ds_read_b128 a[4:7], v13 offset:10240
    ds_read_b64_tr_b16 a[16:17], v12 offset:6144
    ds_read_b64_tr_b16 a[18:19], v12 offset:6656
    v_add_f32 v152, 0x358637bd, v120
    v_rcp_f32 v152, v152
    s_nop 0
    v_mul_f32 v112, v112, v152
    v_mul_f32 v113, v113, v152
    v_mul_f32 v114, v114, v152
    v_mul_f32 v115, v115, v152
    v_mul_f32 v116, v116, v152
    s_waitcnt lgkmcnt(6)
    v_mfma_f32_32x32x16_bf16 v[128:143], a[20:23], v[20:23], v[128:143]
    v_mul_f32 v117, v117, v152
    v_mul_f32 v118, v118, v152
    v_mul_f32 v119, v119, v152
    v_cvt_pk_bf16_f32 v24, v112, v113
    v_cvt_pk_bf16_f32 v25, v114, v115
    v_cvt_pk_bf16_f32 v26, v116, v117
    v_cvt_pk_bf16_f32 v27, v118, v119
    s_waitcnt vmcnt(13)
    s_waitcnt lgkmcnt(5)
    v_mfma_f32_32x32x16_bf16 v[96:111], a[0:3], v[32:35], 0
    ds_read_b128 a[8:11], v13 offset:12288
    ds_read_b64_tr_b16 a[20:21], v12 offset:8192
    ds_read_b64_tr_b16 a[22:23], v12 offset:8704
    v_add_f32 v152, 0x358637bd, v88
    v_rcp_f32 v152, v152
    s_nop 0
    v_mul_f32 v80, v80, v152
    v_mul_f32 v81, v81, v152
    v_mul_f32 v82, v82, v152
    v_mul_f32 v83, v83, v152
    v_mul_f32 v84, v84, v152
    s_waitcnt lgkmcnt(6)
    v_mfma_f32_32x32x16_bf16 v[128:143], a[24:27], v[24:27], v[128:143]
    v_mul_f32 v85, v85, v152
    v_mul_f32 v86, v86, v152
    v_mul_f32 v87, v87, v152
    v_cvt_pk_bf16_f32 v28, v80, v81
    v_cvt_pk_bf16_f32 v29, v82, v83
    v_cvt_pk_bf16_f32 v30, v84, v85
    v_cvt_pk_bf16_f32 v31, v86, v87
    s_waitcnt vmcnt(12)
    s_waitcnt lgkmcnt(5)
    v_mfma_f32_32x32x16_bf16 v[112:127], a[4:7], v[36:39], 0
    ds_read_b128 a[12:15], v13 offset:14336
    ds_read_b64_tr_b16 a[24:25], v12 offset:10240
    ds_read_b64_tr_b16 a[26:27], v12 offset:10752
    v_add_f32 v152, 0x358637bd, v104
    v_rcp_f32 v152, v152
    s_nop 0
    v_mul_f32 v96, v96, v152
    v_mul_f32 v97, v97, v152
    v_mul_f32 v98, v98, v152
    v_mul_f32 v99, v99, v152
    v_mul_f32 v100, v100, v152
    s_waitcnt lgkmcnt(6)
    v_mfma_f32_32x32x16_bf16 v[128:143], a[16:19], v[28:31], v[128:143]
    v_mul_f32 v101, v101, v152
    v_mul_f32 v102, v102, v152
    v_mul_f32 v103, v103, v152
    v_cvt_pk_bf16_f32 v32, v96, v97
    v_cvt_pk_bf16_f32 v33, v98, v99
    v_cvt_pk_bf16_f32 v34, v100, v101
    v_cvt_pk_bf16_f32 v35, v102, v103
    s_waitcnt vmcnt(11)
    s_waitcnt lgkmcnt(5)
    v_mfma_f32_32x32x16_bf16 v[80:95], a[8:11], v[40:43], 0
    ds_read_b128 a[0:3], v13 offset:16384
    ds_read_b64_tr_b16 a[16:17], v12 offset:12288
    ds_read_b64_tr_b16 a[18:19], v12 offset:12800
    v_add_f32 v152, 0x358637bd, v120
    v_rcp_f32 v152, v152
    s_nop 0
    v_mul_f32 v112, v112, v152
    v_mul_f32 v113, v113, v152
    v_mul_f32 v114, v114, v152
    v_mul_f32 v115, v115, v152
    v_mul_f32 v116, v116, v152
    s_waitcnt lgkmcnt(6)
    v_mfma_f32_32x32x16_bf16 v[128:143], a[20:23], v[32:35], v[128:143]
    v_mul_f32 v117, v117, v152
    v_mul_f32 v118, v118, v152
    v_mul_f32 v119, v119, v152
    v_cvt_pk_bf16_f32 v36, v112, v113
    v_cvt_pk_bf16_f32 v37, v114, v115
    v_cvt_pk_bf16_f32 v38, v116, v117
    v_cvt_pk_bf16_f32 v39, v118, v119
    s_waitcnt vmcnt(10)
    s_waitcnt lgkmcnt(5)
    v_mfma_f32_32x32x16_bf16 v[96:111], a[12:15], v[44:47], 0
    ds_read_b128 a[4:7], v13 offset:18432
    ds_read_b64_tr_b16 a[20:21], v12 offset:14336
    ds_read_b64_tr_b16 a[22:23], v12 offset:14848
    v_add_f32 v152, 0x358637bd, v88
    v_rcp_f32 v152, v152
    s_nop 0
    v_mul_f32 v80, v80, v152
    v_mul_f32 v81, v81, v152
    v_mul_f32 v82, v82, v152
    v_mul_f32 v83, v83, v152
    v_mul_f32 v84, v84, v152
    s_waitcnt lgkmcnt(6)
    v_mfma_f32_32x32x16_bf16 v[128:143], a[24:27], v[36:39], v[128:143]
    v_mul_f32 v85, v85, v152
    v_mul_f32 v86, v86, v152
    v_mul_f32 v87, v87, v152
    v_cvt_pk_bf16_f32 v40, v80, v81
    v_cvt_pk_bf16_f32 v41, v82, v83
    v_cvt_pk_bf16_f32 v42, v84, v85
    v_cvt_pk_bf16_f32 v43, v86, v87
    s_waitcnt vmcnt(9)
    s_waitcnt lgkmcnt(5)
    v_mfma_f32_32x32x16_bf16 v[112:127], a[0:3], v[48:51], 0
    ds_read_b128 a[8:11], v13 offset:20480
    ds_read_b64_tr_b16 a[24:25], v12 offset:16384
    ds_read_b64_tr_b16 a[26:27], v12 offset:16896
    v_add_f32 v152, 0x358637bd, v104
    v_rcp_f32 v152, v152
    s_nop 0
    v_mul_f32 v96, v96, v152
    v_mul_f32 v97, v97, v152
    v_mul_f32 v98, v98, v152
    v_mul_f32 v99, v99, v152
    v_mul_f32 v100, v100, v152
    s_waitcnt lgkmcnt(6)
    v_mfma_f32_32x32x16_bf16 v[128:143], a[16:19], v[40:43], v[128:143]
    v_mul_f32 v101, v101, v152
    v_mul_f32 v102, v102, v152
    v_mul_f32 v103, v103, v152
    v_cvt_pk_bf16_f32 v44, v96, v97
    v_cvt_pk_bf16_f32 v45, v98, v99
    v_cvt_pk_bf16_f32 v46, v100, v101
    v_cvt_pk_bf16_f32 v47, v102, v103
    s_waitcnt vmcnt(8)
    s_waitcnt lgkmcnt(5)
    v_mfma_f32_32x32x16_bf16 v[80:95], a[4:7], v[52:55], 0
    ds_read_b128 a[12:15], v13 offset:22528
    ds_read_b64_tr_b16 a[16:17], v12 offset:18432
    ds_read_b64_tr_b16 a[18:19], v12 offset:18944
    v_add_f32 v152, 0x358637bd, v120
    v_rcp_f32 v152, v152
    s_nop 0
    v_mul_f32 v112, v112, v152
    v_mul_f32 v113, v113, v152
    v_mul_f32 v114, v114, v152
    v_mul_f32 v115, v115, v152
    v_mul_f32 v116, v116, v152
    s_waitcnt lgkmcnt(6)
    v_mfma_f32_32x32x16_bf16 v[128:143], a[20:23], v[44:47], v[128:143]
    v_mul_f32 v117, v117, v152
    v_mul_f32 v118, v118, v152
    v_mul_f32 v119, v119, v152
    v_cvt_pk_bf16_f32 v48, v112, v113
    v_cvt_pk_bf16_f32 v49, v114, v115
    v_cvt_pk_bf16_f32 v50, v116, v117
    v_cvt_pk_bf16_f32 v51, v118, v119
    s_waitcnt vmcnt(7)
    s_waitcnt lgkmcnt(5)
    v_mfma_f32_32x32x16_bf16 v[96:111], a[8:11], v[56:59], 0
    ds_read_b128 a[0:3], v13 offset:24576
    ds_read_b64_tr_b16 a[20:21], v12 offset:20480
    ds_read_b64_tr_b16 a[22:23], v12 offset:20992
    v_add_f32 v152, 0x358637bd, v88
    v_rcp_f32 v152, v152
    s_nop 0
    v_mul_f32 v80, v80, v152
    v_mul_f32 v81, v81, v152
    v_mul_f32 v82, v82, v152
    v_mul_f32 v83, v83, v152
    v_mul_f32 v84, v84, v152
    s_waitcnt lgkmcnt(6)
    v_mfma_f32_32x32x16_bf16 v[128:143], a[24:27], v[48:51], v[128:143]
    v_mul_f32 v85, v85, v152
    v_mul_f32 v86, v86, v152
    v_mul_f32 v87, v87, v152
    v_cvt_pk_bf16_f32 v52, v80, v81
    v_cvt_pk_bf16_f32 v53, v82, v83
    v_cvt_pk_bf16_f32 v54, v84, v85
    v_cvt_pk_bf16_f32 v55, v86, v87
    s_waitcnt vmcnt(6)
    s_waitcnt lgkmcnt(5)
    v_mfma_f32_32x32x16_bf16 v[112:127], a[12:15], v[60:63], 0
    ds_read_b128 a[4:7], v13 offset:26624
    ds_read_b64_tr_b16 a[24:25], v12 offset:22528
    ds_read_b64_tr_b16 a[26:27], v12 offset:23040
    v_add_f32 v152, 0x358637bd, v104
    v_rcp_f32 v152, v152
    s_nop 0
    v_mul_f32 v96, v96, v152
    v_mul_f32 v97, v97, v152
    v_mul_f32 v98, v98, v152
    v_mul_f32 v99, v99, v152
    v_mul_f32 v100, v100, v152
    s_waitcnt lgkmcnt(6)
    v_mfma_f32_32x32x16_bf16 v[128:143], a[16:19], v[52:55], v[128:143]
    v_mul_f32 v101, v101, v152
    v_mul_f32 v102, v102, v152
    v_mul_f32 v103, v103, v152
    v_cvt_pk_bf16_f32 v56, v96, v97
    v_cvt_pk_bf16_f32 v57, v98, v99
    v_cvt_pk_bf16_f32 v58, v100, v101
    v_cvt_pk_bf16_f32 v59, v102, v103
    s_waitcnt vmcnt(5)
    s_waitcnt lgkmcnt(5)
    v_mfma_f32_32x32x16_bf16 v[80:95], a[0:3], v[64:67], 0
    ds_read_b128 a[8:11], v13 offset:28672
    ds_read_b64_tr_b16 a[16:17], v12 offset:24576
    ds_read_b64_tr_b16 a[18:19], v12 offset:25088
    v_add_f32 v152, 0x358637bd, v120
    v_rcp_f32 v152, v152
    s_nop 0
    v_mul_f32 v112, v112, v152
    v_mul_f32 v113, v113, v152
    v_mul_f32 v114, v114, v152
    v_mul_f32 v115, v115, v152
    v_mul_f32 v116, v116, v152
    s_waitcnt lgkmcnt(6)
    v_mfma_f32_32x32x16_bf16 v[128:143], a[20:23], v[56:59], v[128:143]
    v_mul_f32 v117, v117, v152
    v_mul_f32 v118, v118, v152
    v_mul_f32 v119, v119, v152
    v_cvt_pk_bf16_f32 v60, v112, v113
    v_cvt_pk_bf16_f32 v61, v114, v115
    v_cvt_pk_bf16_f32 v62, v116, v117
    v_cvt_pk_bf16_f32 v63, v118, v119
    s_waitcnt vmcnt(4)
    s_waitcnt lgkmcnt(5)
    v_mfma_f32_32x32x16_bf16 v[96:111], a[4:7], v[68:71], 0
    ds_read_b128 a[12:15], v13 offset:30720
    ds_read_b64_tr_b16 a[20:21], v12 offset:26624
    ds_read_b64_tr_b16 a[22:23], v12 offset:27136
    v_add_f32 v152, 0x358637bd, v88
    v_rcp_f32 v152, v152
    s_nop 0
    v_mul_f32 v80, v80, v152
    v_mul_f32 v81, v81, v152
    v_mul_f32 v82, v82, v152
    v_mul_f32 v83, v83, v152
    v_mul_f32 v84, v84, v152
    s_waitcnt lgkmcnt(6)
    v_mfma_f32_32x32x16_bf16 v[128:143], a[24:27], v[60:63], v[128:143]
    v_mul_f32 v85, v85, v152
    v_mul_f32 v86, v86, v152
    v_mul_f32 v87, v87, v152
    v_cvt_pk_bf16_f32 v64, v80, v81
    v_cvt_pk_bf16_f32 v65, v82, v83
    v_cvt_pk_bf16_f32 v66, v84, v85
    v_cvt_pk_bf16_f32 v67, v86, v87
    s_waitcnt vmcnt(3)
    s_waitcnt lgkmcnt(5)
    v_mfma_f32_32x32x16_bf16 v[112:127], a[8:11], v[72:75], 0
    ds_read_b64_tr_b16 a[24:25], v12 offset:28672
    ds_read_b64_tr_b16 a[26:27], v12 offset:29184
    v_add_f32 v152, 0x358637bd, v104
    v_rcp_f32 v152, v152
    s_nop 0
    v_mul_f32 v96, v96, v152
    v_mul_f32 v97, v97, v152
    v_mul_f32 v98, v98, v152
    v_mul_f32 v99, v99, v152
    v_mul_f32 v100, v100, v152
    s_waitcnt lgkmcnt(5)
    v_mfma_f32_32x32x16_bf16 v[128:143], a[16:19], v[64:67], v[128:143]
    v_mul_f32 v101, v101, v152
    v_mul_f32 v102, v102, v152
    v_mul_f32 v103, v103, v152
    v_cvt_pk_bf16_f32 v68, v96, v97
    v_cvt_pk_bf16_f32 v69, v98, v99
    v_cvt_pk_bf16_f32 v70, v100, v101
    v_cvt_pk_bf16_f32 v71, v102, v103
    s_waitcnt vmcnt(2)
    s_waitcnt lgkmcnt(4)
    v_mfma_f32_32x32x16_bf16 v[80:95], a[12:15], v[76:79], 0
    ds_read_b64_tr_b16 a[16:17], v12 offset:30720
    ds_read_b64_tr_b16 a[18:19], v12 offset:31232
    v_add_f32 v152, 0x358637bd, v120
    v_rcp_f32 v152, v152
    s_nop 0
    v_mul_f32 v112, v112, v152
    v_mul_f32 v113, v113, v152
    v_mul_f32 v114, v114, v152
    v_mul_f32 v115, v115, v152
    v_mul_f32 v116, v116, v152
    s_waitcnt lgkmcnt(4)
    v_mfma_f32_32x32x16_bf16 v[128:143], a[20:23], v[68:71], v[128:143]
    v_mul_f32 v117, v117, v152
    v_mul_f32 v118, v118, v152
    v_mul_f32 v119, v119, v152
    v_cvt_pk_bf16_f32 v72, v112, v113
    v_cvt_pk_bf16_f32 v73, v114, v115
    v_cvt_pk_bf16_f32 v74, v116, v117
    v_cvt_pk_bf16_f32 v75, v118, v119
    v_add_f32 v152, 0x358637bd, v88
    v_rcp_f32 v152, v152
    s_nop 0
    v_mul_f32 v80, v80, v152
    v_mul_f32 v81, v81, v152
    v_mul_f32 v82, v82, v152
    v_mul_f32 v83, v83, v152
    v_mul_f32 v84, v84, v152
    s_waitcnt lgkmcnt(2)
    v_mfma_f32_32x32x16_bf16 v[128:143], a[24:27], v[72:75], v[128:143]
    v_mul_f32 v85, v85, v152
    v_mul_f32 v86, v86, v152
    v_mul_f32 v87, v87, v152
    v_cvt_pk_bf16_f32 v76, v80, v81
    v_cvt_pk_bf16_f32 v77, v82, v83
    v_cvt_pk_bf16_f32 v78, v84, v85
    v_cvt_pk_bf16_f32 v79, v86, v87
    s_waitcnt lgkmcnt(0)
    v_mfma_f32_32x32x16_bf16 v[128:143], a[16:19], v[76:79], v[128:143]
    s_nop 7
    s_nop 7
    s_barrier
    s_lshl_b32 s28, s24, 11
    s_add_u32 s28, s28, 0
    v_lshlrev_b32 v14, 4, v1
    v_add_u32 v14, s28, v14
    s_xor_b32 s28, s28, 0x2000
    v_lshlrev_b32 v15, 4, v1
    v_add_u32 v15, s28, v15
    s_cmp_eq_u32 s35, 0
    s_cbranch_scc0 PH1_1
    ds_write_b128 v14, v[136:139]
    ds_write_b128 v14, v[140:143] offset:1024
    v_mov_b32 v152, v128
    v_mov_b32 v153, v129
    v_mov_b32 v154, v130
    v_mov_b32 v155, v131
    v_mov_b32 v156, v132
    v_mov_b32 v157, v133
    v_mov_b32 v158, v134
    v_mov_b32 v159, v135
    s_branch PH2_1
PH1_1:
    ds_write_b128 v14, v[128:131]
    ds_write_b128 v14, v[132:135] offset:1024
    v_mov_b32 v152, v136
    v_mov_b32 v153, v137
    v_mov_b32 v154, v138
    v_mov_b32 v155, v139
    v_mov_b32 v156, v140
    v_mov_b32 v157, v141
    v_mov_b32 v158, v142
    v_mov_b32 v159, v143
PH2_1:
    s_waitcnt lgkmcnt(0)
    s_barrier
    ds_read_b128 v[128:131], v15
    ds_read_b128 v[132:135], v15 offset:1024
    s_waitcnt lgkmcnt(0)
    v_add_f32 v152, v152, v128
    v_add_f32 v153, v153, v129
    v_add_f32 v154, v154, v130
    v_add_f32 v155, v155, v131
    v_add_f32 v156, v156, v132
    v_add_f32 v157, v157, v133
    v_add_f32 v158, v158, v134
    v_add_f32 v159, v159, v135
    s_waitcnt vmcnt(0)
    v_lshlrev_b32 v160, 16, v144
    v_and_b32 v161, 0xffff0000, v144
    v_add_f32 v160, v160, v152
    v_add_f32 v161, v161, v153
    v_cvt_pk_bf16_f32 v144, v160, v161
    v_lshlrev_b32 v160, 16, v145
    v_and_b32 v161, 0xffff0000, v145
    v_add_f32 v160, v160, v154
    v_add_f32 v161, v161, v155
    v_cvt_pk_bf16_f32 v145, v160, v161
    v_lshlrev_b32 v160, 16, v146
    v_and_b32 v161, 0xffff0000, v146
    v_add_f32 v160, v160, v156
    v_add_f32 v161, v161, v157
    v_cvt_pk_bf16_f32 v146, v160, v161
    v_lshlrev_b32 v160, 16, v147
    v_and_b32 v161, 0xffff0000, v147
    v_add_f32 v160, v160, v158
    v_add_f32 v161, v161, v159
    v_cvt_pk_bf16_f32 v147, v160, v161
    s_lshl_b32 s29, s26, 11
    s_lshl_b32 s28, s35, 10
    s_add_u32 s29, s29, s28
    s_add_u32 s29, s29, 0x400000
    v_add_u32 v8, s29, v8
    buffer_store_dwordx4 v[144:147], v8, s[20:23], 0 offen
K2_END:
    s_endpgm
.p2align 8
.globl k3_gateup_kernel
.type k3_gateup_kernel,@function
k3_gateup_kernel:
    s_cmp_ge_u32 s2, 240
    s_cbranch_scc1 K3_END
    s_load_dwordx2 s[4:5], s[0:1], 32
    s_load_dwordx2 s[6:7], s[0:1], 40
    s_load_dwordx2 s[8:9], s[0:1], 72
    s_load_dwordx2 s[10:11], s[0:1], 48
    v_and_b32 v1, 63, v0
    v_lshrrev_b32 v4, 6, v0
    s_nop 0
    v_readfirstlane_b32 s24, v4
    v_and_b32 v2, 31, v1
    v_lshrrev_b32 v3, 5, v1
    s_and_b32 s34, s24, 3
    s_lshr_b32 s35, s24, 2
    s_and_b32 s25, s2, 7
    s_lshl_b32 s25, s25, 1
    s_bfe_u32 s26, s2, 0x10003
    s_or_b32 s25, s25, s26
    s_lshr_b32 s26, s2, 4
    s_waitcnt lgkmcnt(0)
    s_mov_b32 s12, s4
    s_mov_b32 s13, s5
    s_mov_b32 s14, 0x158000
    s_mov_b32 s15, 0x00020000
    s_mov_b32 s16, s6
    s_mov_b32 s17, s7
    s_mov_b32 s18, 0x158000
    s_mov_b32 s19, 0x00020000
    s_mov_b32 s20, s8
    s_mov_b32 s21, s9
    s_mov_b32 s22, 0xb60000
    s_mov_b32 s23, 0x00020000
    s_mov_b32 s44, s10
    s_mov_b32 s45, s11
    s_mov_b32 s46, 0x158000
    s_mov_b32 s47, 0x00020000
    s_lshl_b32 s27, s25, 2
    s_add_u32 s27, s27, s34
    s_lshl_b32 s28, s27, 15
    s_lshl_b32 s29, s35, 10
    s_add_u32 s28, s28, s29
    s_add_u32 s28, s28, 0x400000
    v_lshlrev_b32 v9, 4, v1
    v_add_u32 v9, s28, v9
    buffer_load_dwordx4 v[16:19], v9, s[20:23], 0 offen offset:0
    buffer_load_dwordx4 v[20:23], v9, s[20:23], 0 offen offset:2048
    v_add_u32 v9, 0x1000, v9
    buffer_load_dwordx4 v[24:27], v9, s[20:23], 0 offen offset:0
    buffer_load_dwordx4 v[28:31], v9, s[20:23], 0 offen offset:2048
    v_add_u32 v9, 0x1000, v9
    buffer_load_dwordx4 v[32:35], v9, s[20:23], 0 offen offset:0
    buffer_load_dwordx4 v[36:39], v9, s[20:23], 0 offen offset:2048
    v_add_u32 v9, 0x1000, v9
    buffer_load_dwordx4 v[40:43], v9, s[20:23], 0 offen offset:0
    buffer_load_dwordx4 v[44:47], v9, s[20:23], 0 offen offset:2048
    v_add_u32 v9, 0x1000, v9
    buffer_load_dwordx4 v[48:51], v9, s[20:23], 0 offen offset:0
    buffer_load_dwordx4 v[52:55], v9, s[20:23], 0 offen offset:2048
    v_add_u32 v9, 0x1000, v9
    buffer_load_dwordx4 v[56:59], v9, s[20:23], 0 offen offset:0
    buffer_load_dwordx4 v[60:63], v9, s[20:23], 0 offen offset:2048
    v_add_u32 v9, 0x1000, v9
    buffer_load_dwordx4 v[64:67], v9, s[20:23], 0 offen offset:0
    buffer_load_dwordx4 v[68:71], v9, s[20:23], 0 offen offset:2048
    v_add_u32 v9, 0x1000, v9
    buffer_load_dwordx4 v[72:75], v9, s[20:23], 0 offen offset:0
    buffer_load_dwordx4 v[76:79], v9, s[20:23], 0 offen offset:2048
    s_movk_i32 s29, 2752
    s_mov_b32 s28, 43691
    s_mul_i32 s32, s26, 192
    s_lshl_b32 s33, s34, 4
    v_add_u32 v14, 0, v1
    v_mul_lo_u32 v15, v14, s28
    v_lshrrev_b32 v15, 19, v15
    v_mul_u32_u24 v8, 12, v15
    v_sub_u32 v14, v14, v8
    v_add_u32 v15, s33, v15
    v_mul_lo_u32 v200, v15, s29
    v_lshl_add_u32 v200, v14, 4, v200
    v_add_u32 v200, s32, v200
    v_add_u32 v14, 64, v1
    v_mul_lo_u32 v15, v14, s28
    v_lshrrev_b32 v15, 19, v15
    v_mul_u32_u24 v8, 12, v15
    v_sub_u32 v14, v14, v8
    v_add_u32 v15, s33, v15
    v_mul_lo_u32 v201, v15, s29
    v_lshl_add_u32 v201, v14, 4, v201
    v_add_u32 v201, s32, v201
    v_add_u32 v14, 128, v1
    v_mul_lo_u32 v15, v14, s28
    v_lshrrev_b32 v15, 19, v15
    v_mul_u32_u24 v8, 12, v15
    v_sub_u32 v14, v14, v8
    v_add_u32 v15, s33, v15
    v_mul_lo_u32 v202, v15, s29
    v_lshl_add_u32 v202, v14, 4, v202
    v_add_u32 v202, s32, v202
    s_mul_i32 s30, s34, 3072
    s_mul_i32 s28, s35, 12288
    s_add_u32 s30, s30, s28
    s_cmp_eq_u32 s35, 0
    s_cselect_b32 s36, s12, s16
    s_cselect_b32 s37, s13, s17
    s_mov_b32 s38, s14
    s_mov_b32 s39, 0x00020000
    v_bfe_u32 v5, v1, 2, 2
    v_and_b32 v6, 3, v1
    v_bfe_u32 v7, v1, 4, 1
    v_lshl_add_u32 v12, v3, 2, v5
    v_mul_u32_u24 v12, 192, v12
    v_lshl_add_u32 v12, v7, 5, v12
    v_lshl_add_u32 v12, v6, 3, v12
    s_mul_i32 s28, s35, 3072
    v_add_u32 v12, s28, v12
    v_add_u32 v13, 0xc000, v12
    v_add_u32 v11, 0x18000, v12
    s_mov_b32 s31, 0
    s_add_u32 m0, s30, 0
    s_nop 0
    buffer_load_dwordx4 v200, s[36:39], s31 offen lds
    s_mov_b32 s31, 0
    s_add_u32 m0, s30, 1024
    s_nop 0
    buffer_load_dwordx4 v201, s[36:39], s31 offen lds
    s_mov_b32 s31, 0
    s_add_u32 m0, s30, 2048
    s_nop 0
    buffer_load_dwordx4 v202, s[36:39], s31 offen lds
    s_mov_b32 s31, 176128
    s_add_u32 m0, s30, 24576
    s_nop 0
    buffer_load_dwordx4 v200, s[36:39], s31 offen lds
    s_mov_b32 s31, 176128
    s_add_u32 m0, s30, 25600
    s_nop 0
    buffer_load_dwordx4 v201, s[36:39], s31 offen lds
    s_mov_b32 s31, 176128
    s_add_u32 m0, s30, 26624
    s_nop 0
    buffer_load_dwordx4 v202, s[36:39], s31 offen lds
    s_waitcnt vmcnt(6)
    v_mov_b32 v180, 0x3f803f80
    v_mov_b32 v176, 0
    v_mov_b32 v177, 0
    v_mov_b32 v178, 0
    v_mov_b32 v179, 0
    v_dot2c_f32_bf16 v176, v16, v180
    v_dot2c_f32_bf16 v178, v16, v16
    v_dot2c_f32_bf16 v177, v17, v180
    v_dot2c_f32_bf16 v179, v17, v17
    v_dot2c_f32_bf16 v176, v18, v180
    v_dot2c_f32_bf16 v178, v18, v18
    v_dot2c_f32_bf16 v177, v19, v180
    v_dot2c_f32_bf16 v179, v19, v19
    v_dot2c_f32_bf16 v176, v20, v180
    v_dot2c_f32_bf16 v178, v20, v20
    v_dot2c_f32_bf16 v177, v21, v180
    v_dot2c_f32_bf16 v179, v21, v21
    v_dot2c_f32_bf16 v176, v22, v180
    v_dot2c_f32_bf16 v178, v22, v22
    v_dot2c_f32_bf16 v177, v23, v180
    v_dot2c_f32_bf16 v179, v23, v23
    v_dot2c_f32_bf16 v176, v24, v180
    v_dot2c_f32_bf16 v178, v24, v24
    v_dot2c_f32_bf16 v177, v25, v180
    v_dot2c_f32_bf16 v179, v25, v25
    v_dot2c_f32_bf16 v176, v26, v180
    v_dot2c_f32_bf16 v178, v26, v26
    v_dot2c_f32_bf16 v177, v27, v180
    v_dot2c_f32_bf16 v179, v27, v27
    v_dot2c_f32_bf16 v176, v28, v180
    v_dot2c_f32_bf16 v178, v28, v28
    v_dot2c_f32_bf16 v177, v29, v180
    v_dot2c_f32_bf16 v179, v29, v29
    v_dot2c_f32_bf16 v176, v30, v180
    v_dot2c_f32_bf16 v178, v30, v30
    v_dot2c_f32_bf16 v177, v31, v180
    v_dot2c_f32_bf16 v179, v31, v31
    v_dot2c_f32_bf16 v176, v32, v180
    v_dot2c_f32_bf16 v178, v32, v32
    v_dot2c_f32_bf16 v177, v33, v180
    v_dot2c_f32_bf16 v179, v33, v33
    v_dot2c_f32_bf16 v176, v34, v180
    v_dot2c_f32_bf16 v178, v34, v34
    v_dot2c_f32_bf16 v177, v35, v180
    v_dot2c_f32_bf16 v179, v35, v35
    v_dot2c_f32_bf16 v176, v36, v180
    v_dot2c_f32_bf16 v178, v36, v36
    v_dot2c_f32_bf16 v177, v37, v180
    v_dot2c_f32_bf16 v179, v37, v37
    v_dot2c_f32_bf16 v176, v38, v180
    v_dot2c_f32_bf16 v178, v38, v38
    v_dot2c_f32_bf16 v177, v39, v180
    v_dot2c_f32_bf16 v179, v39, v39
    v_dot2c_f32_bf16 v176, v40, v180
    v_dot2c_f32_bf16 v178, v40, v40
    v_dot2c_f32_bf16 v177, v41, v180
    v_dot2c_f32_bf16 v179, v41, v41
    v_dot2c_f32_bf16 v176, v42, v180
    v_dot2c_f32_bf16 v178, v42, v42
    v_dot2c_f32_bf16 v177, v43, v180
    v_dot2c_f32_bf16 v179, v43, v43
    v_dot2c_f32_bf16 v176, v44, v180
    v_dot2c_f32_bf16 v178, v44, v44
    v_dot2c_f32_bf16 v177, v45, v180
    v_dot2c_f32_bf16 v179, v45, v45
    v_dot2c_f32_bf16 v176, v46, v180
    v_dot2c_f32_bf16 v178, v46, v46
    v_dot2c_f32_bf16 v177, v47, v180
    v_dot2c_f32_bf16 v179, v47, v47
    v_dot2c_f32_bf16 v176, v48, v180
    v_dot2c_f32_bf16 v178, v48, v48
    v_dot2c_f32_bf16 v177, v49, v180
    v_dot2c_f32_bf16 v179, v49, v49
    v_dot2c_f32_bf16 v176, v50, v180
    v_dot2c_f32_bf16 v178, v50, v50
    v_dot2c_f32_bf16 v177, v51, v180
    v_dot2c_f32_bf16 v179, v51, v51
    v_dot2c_f32_bf16 v176, v52, v180
    v_dot2c_f32_bf16 v178, v52, v52
    v_dot2c_f32_bf16 v177, v53, v180
    v_dot2c_f32_bf16 v179, v53, v53
    v_dot2c_f32_bf16 v176, v54, v180
    v_dot2c_f32_bf16 v178, v54, v54
    v_dot2c_f32_bf16 v177, v55, v180
    v_dot2c_f32_bf16 v179, v55, v55
    v_dot2c_f32_bf16 v176, v56, v180
    v_dot2c_f32_bf16 v178, v56, v56
    v_dot2c_f32_bf16 v177, v57, v180
    v_dot2c_f32_bf16 v179, v57, v57
    v_dot2c_f32_bf16 v176, v58, v180
    v_dot2c_f32_bf16 v178, v58, v58
    v_dot2c_f32_bf16 v177, v59, v180
    v_dot2c_f32_bf16 v179, v59, v59
    v_dot2c_f32_bf16 v176, v60, v180
    v_dot2c_f32_bf16 v178, v60, v60
    v_dot2c_f32_bf16 v177, v61, v180
    v_dot2c_f32_bf16 v179, v61, v61
    v_dot2c_f32_bf16 v176, v62, v180
    v_dot2c_f32_bf16 v178, v62, v62
    v_dot2c_f32_bf16 v177, v63, v180
    v_dot2c_f32_bf16 v179, v63, v63
    v_dot2c_f32_bf16 v176, v64, v180
    v_dot2c_f32_bf16 v178, v64, v64
    v_dot2c_f32_bf16 v177, v65, v180
    v_dot2c_f32_bf16 v179, v65, v65
    v_dot2c_f32_bf16 v176, v66, v180
    v_dot2c_f32_bf16 v178, v66, v66
    v_dot2c_f32_bf16 v177, v67, v180
    v_dot2c_f32_bf16 v179, v67, v67
    v_dot2c_f32_bf16 v176, v68, v180
    v_dot2c_f32_bf16 v178, v68, v68
    v_dot2c_f32_bf16 v177, v69, v180
    v_dot2c_f32_bf16 v179, v69, v69
    v_dot2c_f32_bf16 v176, v70, v180
    v_dot2c_f32_bf16 v178, v70, v70
    v_dot2c_f32_bf16 v177, v71, v180
    v_dot2c_f32_bf16 v179, v71, v71
    v_dot2c_f32_bf16 v176, v72, v180
    v_dot2c_f32_bf16 v178, v72, v72
    v_dot2c_f32_bf16 v177, v73, v180
    v_dot2c_f32_bf16 v179, v73, v73
    v_dot2c_f32_bf16 v176, v74, v180
    v_dot2c_f32_bf16 v178, v74, v74
    v_dot2c_f32_bf16 v177, v75, v180
    v_dot2c_f32_bf16 v179, v75, v75
    v_dot2c_f32_bf16 v176, v76, v180
    v_dot2c_f32_bf16 v178, v76, v76
    v_dot2c_f32_bf16 v177, v77, v180
    v_dot2c_f32_bf16 v179, v77, v77
    v_dot2c_f32_bf16 v176, v78, v180
    v_dot2c_f32_bf16 v178, v78, v78
    v_dot2c_f32_bf16 v177, v79, v180
    v_dot2c_f32_bf16 v179, v79, v79
    s_nop 3
    v_add_f32 v176, v176, v177
    v_add_f32 v178, v178, v179
    v_mov_b32 v177, v176
    v_mov_b32 v179, v178
    s_nop 1
    v_permlane32_swap_b32 v176, v177
    v_permlane32_swap_b32 v178, v179
    s_nop 1
    v_add_f32 v176, v176, v177
    v_add_f32 v177, v178, v179
    s_lshl_b32 s28, s24, 8
    s_add_u32 s28, s28, 147456
    v_lshlrev_b32 v8, 3, v2
    v_add_u32 v9, s28, v8
    s_xor_b32 s28, s28, 0x400
    v_add_u32 v8, s28, v8
    ds_write_b64 v9, v[176:177]
    s_waitcnt lgkmcnt(0)
    s_barrier
    ds_read_b64 v[178:179], v8
    s_waitcnt lgkmcnt(0)
    v_add_f32 v176, v176, v178
    v_add_f32 v178, v177, v179
    v_mul_f32 v176, 0x3b000000, v176
    v_mul_f32 v178, 0x3b000000, v178
    v_fma_f32 v178, -v176, v176, v178
    v_max_f32 v178, 0, v178
    v_add_f32 v178, 0x3727c5ac, v178
    v_rsq_f32 v14, v178
    s_nop 0
    v_mul_f32 v15, v176, v14
    v_sub_f32 v15, 0, v15
    v_lshlrev_b32 v176, 16, v16
    v_and_b32 v177, 0xffff0000, v16
    v_fma_f32 v176, v176, v14, v15
    v_fma_f32 v177, v177, v14, v15
    v_cvt_pk_bf16_f32 v16, v176, v177
    v_lshlrev_b32 v176, 16, v17
    v_and_b32 v177, 0xffff0000, v17
    v_fma_f32 v176, v176, v14, v15
    v_fma_f32 v177, v177, v14, v15
    v_cvt_pk_bf16_f32 v17, v176, v177
    v_lshlrev_b32 v176, 16, v18
    v_and_b32 v177, 0xffff0000, v18
    v_fma_f32 v176, v176, v14, v15
    v_fma_f32 v177, v177, v14, v15
    v_cvt_pk_bf16_f32 v18, v176, v177
    v_lshlrev_b32 v176, 16, v19
    v_and_b32 v177, 0xffff0000, v19
    v_fma_f32 v176, v176, v14, v15
    v_fma_f32 v177, v177, v14, v15
    v_cvt_pk_bf16_f32 v19, v176, v177
    s_waitcnt vmcnt(3)
    s_barrier
    ds_read_b64_tr_b16 a[0:1], v12 offset:0
    ds_read_b64_tr_b16 a[2:3], v12 offset:1536
    ds_read_b64_tr_b16 a[4:5], v12 offset:64
    ds_read_b64_tr_b16 a[6:7], v12 offset:1600
    ds_read_b64_tr_b16 a[8:9], v12 offset:128
    ds_read_b64_tr_b16 a[10:11], v12 offset:1664
    ds_read_b64_tr_b16 a[12:13], v12 offset:12288
    ds_read_b64_tr_b16 a[14:15], v12 offset:13824
    ds_read_b64_tr_b16 a[16:17], v12 offset:12352
    ds_read_b64_tr_b16 a[18:19], v12 offset:13888
    ds_read_b64_tr_b16 a[20:21], v12 offset:12416
    ds_read_b64_tr_b16 a[22:23], v12 offset:13952
    s_waitcnt lgkmcnt(0)
    v_mfma_f32_32x32x16_bf16 v[80:95], a[0:3], v[16:19], 0
    ds_read_b64_tr_b16 a[24:25], v12 offset:6144
    v_lshlrev_b32 v176, 16, v20
    v_lshlrev_b32 v178, 16, v21
    v_lshlrev_b32 v180, 16, v22
    ds_read_b64_tr_b16 a[26:27], v12 offset:7680
    v_lshlrev_b32 v182, 16, v23
    v_and_b32 v177, 0xffff0000, v20
    v_mfma_f32_32x32x16_bf16 v[96:111], a[4:7], v[16:19], 0
    v_and_b32 v179, 0xffff0000, v21
    ds_read_b64_tr_b16 a[28:29], v12 offset:6208
    v_and_b32 v181, 0xffff0000, v22
    v_and_b32 v183, 0xffff0000, v23
    ds_read_b64_tr_b16 a[30:31], v12 offset:7744
    v_fma_f32 v176, v176, v14, v15
    v_fma_f32 v178, v178, v14, v15
    v_mfma_f32_32x32x16_bf16 v[112:127], a[8:11], v[16:19], 0
    v_fma_f32 v180, v180, v14, v15
    ds_read_b64_tr_b16 a[32:33], v12 offset:6272
    v_fma_f32 v182, v182, v14, v15
    v_fma_f32 v177, v177, v14, v15
    v_fma_f32 v179, v179, v14, v15
    ds_read_b64_tr_b16 a[34:35], v12 offset:7808
    v_fma_f32 v181, v181, v14, v15
    v_fma_f32 v183, v183, v14, v15
    v_mfma_f32_32x32x16_bf16 v[128:143], a[12:15], v[16:19], 0
    ds_read_b64_tr_b16 a[36:37], v12 offset:18432
    v_cvt_pk_bf16_f32 v20, v176, v177
    v_cvt_pk_bf16_f32 v21, v178, v179
    v_cvt_pk_bf16_f32 v22, v180, v181
    ds_read_b64_tr_b16 a[38:39], v12 offset:19968
    v_cvt_pk_bf16_f32 v23, v182, v183
    s_mov_b32 s31, 352256
    v_mfma_f32_32x32x16_bf16 v[144:159], a[16:19], v[16:19], 0
    s_add_u32 m0, s30, 49152
    ds_read_b64_tr_b16 a[40:41], v12 offset:18496
    s_nop 0
    buffer_load_dwordx4 v200, s[36:39], s31 offen lds
    ds_read_b64_tr_b16 a[42:43], v12 offset:20032
    s_mov_b32 s31, 352256
    s_add_u32 m0, s30, 50176
    v_mfma_f32_32x32x16_bf16 v[160:175], a[20:23], v[16:19], 0
    s_nop 0
    ds_read_b64_tr_b16 a[44:45], v12 offset:18560
    buffer_load_dwordx4 v201, s[36:39], s31 offen lds
    s_mov_b32 s31, 352256
    s_add_u32 m0, s30, 51200
    ds_read_b64_tr_b16 a[46:47], v12 offset:20096
    s_nop 0
    buffer_load_dwordx4 v202, s[36:39], s31 offen lds
    s_waitcnt lgkmcnt(0)
    s_waitcnt vmcnt(3)
    s_barrier
    v_mfma_f32_32x32x16_bf16 v[80:95], a[24:27], v[20:23], v[80:95]
    ds_read_b64_tr_b16 a[0:1], v12 offset:24576
    v_lshlrev_b32 v176, 16, v24
    v_lshlrev_b32 v178, 16, v25
    v_lshlrev_b32 v180, 16, v26
    ds_read_b64_tr_b16 a[2:3], v12 offset:26112
    v_lshlrev_b32 v182, 16, v27
    v_and_b32 v177, 0xffff0000, v24
    v_mfma_f32_32x32x16_bf16 v[96:111], a[28:31], v[20:23], v[96:111]
    v_and_b32 v179, 0xffff0000, v25
    ds_read_b64_tr_b16 a[4:5], v12 offset:24640
    v_and_b32 v181, 0xffff0000, v26
    v_and_b32 v183, 0xffff0000, v27
    ds_read_b64_tr_b16 a[6:7], v12 offset:26176
    v_fma_f32 v176, v176, v14, v15
    v_fma_f32 v178, v178, v14, v15
    v_mfma_f32_32x32x16_bf16 v[112:127], a[32:35], v[20:23], v[112:127]
    v_fma_f32 v180, v180, v14, v15
    ds_read_b64_tr_b16 a[8:9], v12 offset:24704
    v_fma_f32 v182, v182, v14, v15
    v_fma_f32 v177, v177, v14, v15
    v_fma_f32 v179, v179, v14, v15
    ds_read_b64_tr_b16 a[10:11], v12 offset:26240
    v_fma_f32 v181, v181, v14, v15
    v_fma_f32 v183, v183, v14, v15
    v_mfma_f32_32x32x16_bf16 v[128:143], a[36:39], v[20:23], v[128:143]
    ds_read_b64_tr_b16 a[12:13], v12 offset:36864
    v_cvt_pk_bf16_f32 v24, v176, v177
    v_cvt_pk_bf16_f32 v25, v178, v179
    v_cvt_pk_bf16_f32 v26, v180, v181
    ds_read_b64_tr_b16 a[14:15], v12 offset:38400
    v_cvt_pk_bf16_f32 v27, v182, v183
    s_mov_b32 s31, 528384
    v_mfma_f32_32x32x16_bf16 v[144:159], a[40:43], v[20:23], v[144:159]
    s_add_u32 m0, s30, 73728
    ds_read_b64_tr_b16 a[16:17], v12 offset:36928
    s_nop 0
    buffer_load_dwordx4 v200, s[36:39], s31 offen lds
    ds_read_b64_tr_b16 a[18:19], v12 offset:38464
    s_mov_b32 s31, 528384
    s_add_u32 m0, s30, 74752
    v_mfma_f32_32x32x16_bf16 v[160:175], a[44:47], v[20:23], v[160:175]
    s_nop 0
    ds_read_b64_tr_b16 a[20:21], v12 offset:36992
    buffer_load_dwordx4 v201, s[36:39], s31 offen lds
    s_mov_b32 s31, 528384
    s_add_u32 m0, s30, 75776
    ds_read_b64_tr_b16 a[22:23], v12 offset:38528
    s_nop 0
    buffer_load_dwordx4 v202, s[36:39], s31 offen lds
    s_waitcnt lgkmcnt(0)
    v_mfma_f32_32x32x16_bf16 v[80:95], a[0:3], v[24:27], v[80:95]
    ds_read_b64_tr_b16 a[24:25], v12 offset:30720
    v_lshlrev_b32 v176, 16, v28
    v_lshlrev_b32 v178, 16, v29
    ds_read_b64_tr_b16 a[26:27], v12 offset:32256
    v_lshlrev_b32 v180, 16, v30
    v_mfma_f32_32x32x16_bf16 v[96:111], a[4:7], v[24:27], v[96:111]
    v_lshlrev_b32 v182, 16, v31
    ds_read_b64_tr_b16 a[28:29], v12 offset:30784
    v_and_b32 v177, 0xffff0000, v28
    ds_read_b64_tr_b16 a[30:31], v12 offset:32320
    v_and_b32 v179, 0xffff0000, v29
    v_mfma_f32_32x32x16_bf16 v[112:127], a[8:11], v[24:27], v[112:127]
    v_and_b32 v181, 0xffff0000, v30
    ds_read_b64_tr_b16 a[32:33], v12 offset:30848
    v_and_b32 v183, 0xffff0000, v31
    v_fma_f32 v176, v176, v14, v15
    ds_read_b64_tr_b16 a[34:35], v12 offset:32384
    v_fma_f32 v178, v178, v14, v15
    v_mfma_f32_32x32x16_bf16 v[128:143], a[12:15], v[24:27], v[128:143]
    ds_read_b64_tr_b16 a[36:37], v12 offset:43008
    v_fma_f32 v180, v180, v14, v15
    v_fma_f32 v182, v182, v14, v15
    ds_read_b64_tr_b16 a[38:39], v12 offset:44544
    v_fma_f32 v177, v177, v14, v15
    v_mfma_f32_32x32x16_bf16 v[144:159], a[16:19], v[24:27], v[144:159]
    v_fma_f32 v179, v179, v14, v15
    ds_read_b64_tr_b16 a[40:41], v12 offset:43072
    v_fma_f32 v181, v181, v14, v15
    ds_read_b64_tr_b16 a[42:43], v12 offset:44608
    v_fma_f32 v183, v183, v14, v15
    v_mfma_f32_32x32x16_bf16 v[160:175], a[20:23], v[24:27], v[160:175]
    v_cvt_pk_bf16_f32 v28, v176, v177
    ds_read_b64_tr_b16 a[44:45], v12 offset:43136
    v_cvt_pk_bf16_f32 v29, v178, v179
    v_cvt_pk_bf16_f32 v30, v180, v181
    ds_read_b64_tr_b16 a[46:47], v12 offset:44672
    v_cvt_pk_bf16_f32 v31, v182, v183
    s_waitcnt lgkmcnt(0)
    s_waitcnt vmcnt(3)
    s_barrier
    v_mfma_f32_32x32x16_bf16 v[80:95], a[24:27], v[28:31], v[80:95]
    ds_read_b64_tr_b16 a[0:1], v13 offset:0
    v_lshlrev_b32 v176, 16, v32
    v_lshlrev_b32 v178, 16, v33
    v_lshlrev_b32 v180, 16, v34
    ds_read_b64_tr_b16 a[2:3], v13 offset:1536
    v_lshlrev_b32 v182, 16, v35
    v_and_b32 v177, 0xffff0000, v32
    v_mfma_f32_32x32x16_bf16 v[96:111], a[28:31], v[28:31], v[96:111]
    v_and_b32 v179, 0xffff0000, v33
    ds_read_b64_tr_b16 a[4:5], v13 offset:64
    v_and_b32 v181, 0xffff0000, v34
    v_and_b32 v183, 0xffff0000, v35
    ds_read_b64_tr_b16 a[6:7], v13 offset:1600
    v_fma_f32 v176, v176, v14, v15
    v_fma_f32 v178, v178, v14, v15
    v_mfma_f32_32x32x16_bf16 v[112:127], a[32:35], v[28:31], v[112:127]
    v_fma_f32 v180, v180, v14, v15
    ds_read_b64_tr_b16 a[8:9], v13 offset:128
    v_fma_f32 v182, v182, v14, v15
    v_fma_f32 v177, v177, v14, v15
    v_fma_f32 v179, v179, v14, v15
    ds_read_b64_tr_b16 a[10:11], v13 offset:1664
    v_fma_f32 v181, v181, v14, v15
    v_fma_f32 v183, v183, v14, v15
    v_mfma_f32_32x32x16_bf16 v[128:143], a[36:39], v[28:31], v[128:143]
    ds_read_b64_tr_b16 a[12:13], v13 offset:12288
    v_cvt_pk_bf16_f32 v32, v176, v177
    v_cvt_pk_bf16_f32 v33, v178, v179
    v_cvt_pk_bf16_f32 v34, v180, v181
    ds_read_b64_tr_b16 a[14:15], v13 offset:13824
    v_cvt_pk_bf16_f32 v35, v182, v183
    s_mov_b32 s31, 704512
    v_mfma_f32_32x32x16_bf16 v[144:159], a[40:43], v[28:31], v[144:159]
    s_add_u32 m0, s30, 98304
    ds_read_b64_tr_b16 a[16:17], v13 offset:12352
    s_nop 0
    buffer_load_dwordx4 v200, s[36:39], s31 offen lds
    ds_read_b64_tr_b16 a[18:19], v13 offset:13888
    s_mov_b32 s31, 704512
    s_add_u32 m0, s30, 99328
    v_mfma_f32_32x32x16_bf16 v[160:175], a[44:47], v[28:31], v[160:175]
    s_nop 0
    ds_read_b64_tr_b16 a[20:21], v13 offset:12416
    buffer_load_dwordx4 v201, s[36:39], s31 offen lds
    s_mov_b32 s31, 704512
    s_add_u32 m0, s30, 100352
    ds_read_b64_tr_b16 a[22:23], v13 offset:13952
    s_nop 0
    buffer_load_dwordx4 v202, s[36:39], s31 offen lds
    s_waitcnt lgkmcnt(0)
    v_mfma_f32_32x32x16_bf16 v[80:95], a[0:3], v[32:35], v[80:95]
    ds_read_b64_tr_b16 a[24:25], v13 offset:6144
    v_lshlrev_b32 v176, 16, v36
    v_lshlrev_b32 v178, 16, v37
    ds_read_b64_tr_b16 a[26:27], v13 offset:7680
    v_lshlrev_b32 v180, 16, v38
    v_mfma_f32_32x32x16_bf16 v[96:111], a[4:7], v[32:35], v[96:111]
    v_lshlrev_b32 v182, 16, v39
    ds_read_b64_tr_b16 a[28:29], v13 offset:6208
    v_and_b32 v177, 0xffff0000, v36
    ds_read_b64_tr_b16 a[30:31], v13 offset:7744
    v_and_b32 v179, 0xffff0000, v37
    v_mfma_f32_32x32x16_bf16 v[112:127], a[8:11], v[32:35], v[112:127]
    v_and_b32 v181, 0xffff0000, v38
    ds_read_b64_tr_b16 a[32:33], v13 offset:6272
    v_and_b32 v183, 0xffff0000, v39
    v_fma_f32 v176, v176, v14, v15
    ds_read_b64_tr_b16 a[34:35], v13 offset:7808
    v_fma_f32 v178, v178, v14, v15
    v_mfma_f32_32x32x16_bf16 v[128:143], a[12:15], v[32:35], v[128:143]
    ds_read_b64_tr_b16 a[36:37], v13 offset:18432
    v_fma_f32 v180, v180, v14, v15
    v_fma_f32 v182, v182, v14, v15
    ds_read_b64_tr_b16 a[38:39], v13 offset:19968
    v_fma_f32 v177, v177, v14, v15
    v_mfma_f32_32x32x16_bf16 v[144:159], a[16:19], v[32:35], v[144:159]
    v_fma_f32 v179, v179, v14, v15
    ds_read_b64_tr_b16 a[40:41], v13 offset:18496
    v_fma_f32 v181, v181, v14, v15
    ds_read_b64_tr_b16 a[42:43], v13 offset:20032
    v_fma_f32 v183, v183, v14, v15
    v_mfma_f32_32x32x16_bf16 v[160:175], a[20:23], v[32:35], v[160:175]
    v_cvt_pk_bf16_f32 v36, v176, v177
    ds_read_b64_tr_b16 a[44:45], v13 offset:18560
    v_cvt_pk_bf16_f32 v37, v178, v179
    v_cvt_pk_bf16_f32 v38, v180, v181
    ds_read_b64_tr_b16 a[46:47], v13 offset:20096
    v_cvt_pk_bf16_f32 v39, v182, v183
    s_waitcnt lgkmcnt(0)
    s_waitcnt vmcnt(3)
    s_barrier
    v_mfma_f32_32x32x16_bf16 v[80:95], a[24:27], v[36:39], v[80:95]
    ds_read_b64_tr_b16 a[0:1], v13 offset:24576
    v_lshlrev_b32 v176, 16, v40
    v_lshlrev_b32 v178, 16, v41
    v_lshlrev_b32 v180, 16, v42
    ds_read_b64_tr_b16 a[2:3], v13 offset:26112
    v_lshlrev_b32 v182, 16, v43
    v_and_b32 v177, 0xffff0000, v40
    v_mfma_f32_32x32x16_bf16 v[96:111], a[28:31], v[36:39], v[96:111]
    v_and_b32 v179, 0xffff0000, v41
    ds_read_b64_tr_b16 a[4:5], v13 offset:24640
    v_and_b32 v181, 0xffff0000, v42
    v_and_b32 v183, 0xffff0000, v43
    ds_read_b64_tr_b16 a[6:7], v13 offset:26176
    v_fma_f32 v176, v176, v14, v15
    v_fma_f32 v178, v178, v14, v15
    v_mfma_f32_32x32x16_bf16 v[112:127], a[32:35], v[36:39], v[112:127]
    v_fma_f32 v180, v180, v14, v15
    ds_read_b64_tr_b16 a[8:9], v13 offset:24704
    v_fma_f32 v182, v182, v14, v15
    v_fma_f32 v177, v177, v14, v15
    v_fma_f32 v179, v179, v14, v15
    ds_read_b64_tr_b16 a[10:11], v13 offset:26240
    v_fma_f32 v181, v181, v14, v15
    v_fma_f32 v183, v183, v14, v15
    v_mfma_f32_32x32x16_bf16 v[128:143], a[36:39], v[36:39], v[128:143]
    ds_read_b64_tr_b16 a[12:13], v13 offset:36864
    v_cvt_pk_bf16_f32 v40, v176, v177
    v_cvt_pk_bf16_f32 v41, v178, v179
    v_cvt_pk_bf16_f32 v42, v180, v181
    ds_read_b64_tr_b16 a[14:15], v13 offset:38400
    v_cvt_pk_bf16_f32 v43, v182, v183
    s_mov_b32 s31, 880640
    v_mfma_f32_32x32x16_bf16 v[144:159], a[40:43], v[36:39], v[144:159]
    s_add_u32 m0, s30, 122880
    ds_read_b64_tr_b16 a[16:17], v13 offset:36928
    s_nop 0
    buffer_load_dwordx4 v200, s[36:39], s31 offen lds
    ds_read_b64_tr_b16 a[18:19], v13 offset:38464
    s_mov_b32 s31, 880640
    s_add_u32 m0, s30, 123904
    v_mfma_f32_32x32x16_bf16 v[160:175], a[44:47], v[36:39], v[160:175]
    s_nop 0
    ds_read_b64_tr_b16 a[20:21], v13 offset:36992
    buffer_load_dwordx4 v201, s[36:39], s31 offen lds
    s_mov_b32 s31, 880640
    s_add_u32 m0, s30, 124928
    ds_read_b64_tr_b16 a[22:23], v13 offset:38528
    s_nop 0
    buffer_load_dwordx4 v202, s[36:39], s31 offen lds
    s_waitcnt lgkmcnt(0)
    v_mfma_f32_32x32x16_bf16 v[80:95], a[0:3], v[40:43], v[80:95]
    ds_read_b64_tr_b16 a[24:25], v13 offset:30720
    v_lshlrev_b32 v176, 16, v44
    v_lshlrev_b32 v178, 16, v45
    ds_read_b64_tr_b16 a[26:27], v13 offset:32256
    v_lshlrev_b32 v180, 16, v46
    v_mfma_f32_32x32x16_bf16 v[96:111], a[4:7], v[40:43], v[96:111]
    v_lshlrev_b32 v182, 16, v47
    ds_read_b64_tr_b16 a[28:29], v13 offset:30784
    v_and_b32 v177, 0xffff0000, v44
    ds_read_b64_tr_b16 a[30:31], v13 offset:32320
    v_and_b32 v179, 0xffff0000, v45
    v_mfma_f32_32x32x16_bf16 v[112:127], a[8:11], v[40:43], v[112:127]
    v_and_b32 v181, 0xffff0000, v46
    ds_read_b64_tr_b16 a[32:33], v13 offset:30848
    v_and_b32 v183, 0xffff0000, v47
    v_fma_f32 v176, v176, v14, v15
    ds_read_b64_tr_b16 a[34:35], v13 offset:32384
    v_fma_f32 v178, v178, v14, v15
    v_mfma_f32_32x32x16_bf16 v[128:143], a[12:15], v[40:43], v[128:143]
    ds_read_b64_tr_b16 a[36:37], v13 offset:43008
    v_fma_f32 v180, v180, v14, v15
    v_fma_f32 v182, v182, v14, v15
    ds_read_b64_tr_b16 a[38:39], v13 offset:44544
    v_fma_f32 v177, v177, v14, v15
    v_mfma_f32_32x32x16_bf16 v[144:159], a[16:19], v[40:43], v[144:159]
    v_fma_f32 v179, v179, v14, v15
    ds_read_b64_tr_b16 a[40:41], v13 offset:43072
    v_fma_f32 v181, v181, v14, v15
    ds_read_b64_tr_b16 a[42:43], v13 offset:44608
    v_fma_f32 v183, v183, v14, v15
    v_mfma_f32_32x32x16_bf16 v[160:175], a[20:23], v[40:43], v[160:175]
    v_cvt_pk_bf16_f32 v44, v176, v177
    ds_read_b64_tr_b16 a[44:45], v13 offset:43136
    v_cvt_pk_bf16_f32 v45, v178, v179
    v_cvt_pk_bf16_f32 v46, v180, v181
    ds_read_b64_tr_b16 a[46:47], v13 offset:44672
    v_cvt_pk_bf16_f32 v47, v182, v183
    s_waitcnt lgkmcnt(0)
    s_waitcnt vmcnt(3)
    s_barrier
    v_mfma_f32_32x32x16_bf16 v[80:95], a[24:27], v[44:47], v[80:95]
    ds_read_b64_tr_b16 a[0:1], v11 offset:0
    v_lshlrev_b32 v176, 16, v48
    v_lshlrev_b32 v178, 16, v49
    v_lshlrev_b32 v180, 16, v50
    ds_read_b64_tr_b16 a[2:3], v11 offset:1536
    v_lshlrev_b32 v182, 16, v51
    v_and_b32 v177, 0xffff0000, v48
    v_mfma_f32_32x32x16_bf16 v[96:111], a[28:31], v[44:47], v[96:111]
    v_and_b32 v179, 0xffff0000, v49
    ds_read_b64_tr_b16 a[4:5], v11 offset:64
    v_and_b32 v181, 0xffff0000, v50
    v_and_b32 v183, 0xffff0000, v51
    ds_read_b64_tr_b16 a[6:7], v11 offset:1600
    v_fma_f32 v176, v176, v14, v15
    v_fma_f32 v178, v178, v14, v15
    v_mfma_f32_32x32x16_bf16 v[112:127], a[32:35], v[44:47], v[112:127]
    v_fma_f32 v180, v180, v14, v15
    ds_read_b64_tr_b16 a[8:9], v11 offset:128
    v_fma_f32 v182, v182, v14, v15
    v_fma_f32 v177, v177, v14, v15
    v_fma_f32 v179, v179, v14, v15
    ds_read_b64_tr_b16 a[10:11], v11 offset:1664
    v_fma_f32 v181, v181, v14, v15
    v_fma_f32 v183, v183, v14, v15
    v_mfma_f32_32x32x16_bf16 v[128:143], a[36:39], v[44:47], v[128:143]
    ds_read_b64_tr_b16 a[12:13], v11 offset:12288
    v_cvt_pk_bf16_f32 v48, v176, v177
    v_cvt_pk_bf16_f32 v49, v178, v179
    v_cvt_pk_bf16_f32 v50, v180, v181
    ds_read_b64_tr_b16 a[14:15], v11 offset:13824
    v_cvt_pk_bf16_f32 v51, v182, v183
    s_mov_b32 s31, 1056768
    v_mfma_f32_32x32x16_bf16 v[144:159], a[40:43], v[44:47], v[144:159]
    s_add_u32 m0, s30, 0
    ds_read_b64_tr_b16 a[16:17], v11 offset:12352
    s_nop 0
    buffer_load_dwordx4 v200, s[36:39], s31 offen lds
    ds_read_b64_tr_b16 a[18:19], v11 offset:13888
    s_mov_b32 s31, 1056768
    s_add_u32 m0, s30, 1024
    v_mfma_f32_32x32x16_bf16 v[160:175], a[44:47], v[44:47], v[160:175]
    s_nop 0
    ds_read_b64_tr_b16 a[20:21], v11 offset:12416
    buffer_load_dwordx4 v201, s[36:39], s31 offen lds
    s_mov_b32 s31, 1056768
    s_add_u32 m0, s30, 2048
    ds_read_b64_tr_b16 a[22:23], v11 offset:13952
    s_nop 0
    buffer_load_dwordx4 v202, s[36:39], s31 offen lds
    s_waitcnt lgkmcnt(0)
    v_mfma_f32_32x32x16_bf16 v[80:95], a[0:3], v[48:51], v[80:95]
    ds_read_b64_tr_b16 a[24:25], v11 offset:6144
    v_lshlrev_b32 v176, 16, v52
    v_lshlrev_b32 v178, 16, v53
    ds_read_b64_tr_b16 a[26:27], v11 offset:7680
    v_lshlrev_b32 v180, 16, v54
    v_mfma_f32_32x32x16_bf16 v[96:111], a[4:7], v[48:51], v[96:111]
    v_lshlrev_b32 v182, 16, v55
    ds_read_b64_tr_b16 a[28:29], v11 offset:6208
    v_and_b32 v177, 0xffff0000, v52
    ds_read_b64_tr_b16 a[30:31], v11 offset:7744
    v_and_b32 v179, 0xffff0000, v53
    v_mfma_f32_32x32x16_bf16 v[112:127], a[8:11], v[48:51], v[112:127]
    v_and_b32 v181, 0xffff0000, v54
    ds_read_b64_tr_b16 a[32:33], v11 offset:6272
    v_and_b32 v183, 0xffff0000, v55
    v_fma_f32 v176, v176, v14, v15
    ds_read_b64_tr_b16 a[34:35], v11 offset:7808
    v_fma_f32 v178, v178, v14, v15
    v_mfma_f32_32x32x16_bf16 v[128:143], a[12:15], v[48:51], v[128:143]
    ds_read_b64_tr_b16 a[36:37], v11 offset:18432
    v_fma_f32 v180, v180, v14, v15
    v_fma_f32 v182, v182, v14, v15
    ds_read_b64_tr_b16 a[38:39], v11 offset:19968
    v_fma_f32 v177, v177, v14, v15
    v_mfma_f32_32x32x16_bf16 v[144:159], a[16:19], v[48:51], v[144:159]
    v_fma_f32 v179, v179, v14, v15
    ds_read_b64_tr_b16 a[40:41], v11 offset:18496
    v_fma_f32 v181, v181, v14, v15
    ds_read_b64_tr_b16 a[42:43], v11 offset:20032
    v_fma_f32 v183, v183, v14, v15
    v_mfma_f32_32x32x16_bf16 v[160:175], a[20:23], v[48:51], v[160:175]
    v_cvt_pk_bf16_f32 v52, v176, v177
    ds_read_b64_tr_b16 a[44:45], v11 offset:18560
    v_cvt_pk_bf16_f32 v53, v178, v179
    v_cvt_pk_bf16_f32 v54, v180, v181
    ds_read_b64_tr_b16 a[46:47], v11 offset:20096
    v_cvt_pk_bf16_f32 v55, v182, v183
    s_waitcnt lgkmcnt(0)
    s_waitcnt vmcnt(3)
    s_barrier
    v_mfma_f32_32x32x16_bf16 v[80:95], a[24:27], v[52:55], v[80:95]
    ds_read_b64_tr_b16 a[0:1], v11 offset:24576
    v_lshlrev_b32 v176, 16, v56
    v_lshlrev_b32 v178, 16, v57
    v_lshlrev_b32 v180, 16, v58
    ds_read_b64_tr_b16 a[2:3], v11 offset:26112
    v_lshlrev_b32 v182, 16, v59
    v_and_b32 v177, 0xffff0000, v56
    v_mfma_f32_32x32x16_bf16 v[96:111], a[28:31], v[52:55], v[96:111]
    v_and_b32 v179, 0xffff0000, v57
    ds_read_b64_tr_b16 a[4:5], v11 offset:24640
    v_and_b32 v181, 0xffff0000, v58
    v_and_b32 v183, 0xffff0000, v59
    ds_read_b64_tr_b16 a[6:7], v11 offset:26176
    v_fma_f32 v176, v176, v14, v15
    v_fma_f32 v178, v178, v14, v15
    v_mfma_f32_32x32x16_bf16 v[112:127], a[32:35], v[52:55], v[112:127]
    v_fma_f32 v180, v180, v14, v15
    ds_read_b64_tr_b16 a[8:9], v11 offset:24704
    v_fma_f32 v182, v182, v14, v15
    v_fma_f32 v177, v177, v14, v15
    v_fma_f32 v179, v179, v14, v15
    ds_read_b64_tr_b16 a[10:11], v11 offset:26240
    v_fma_f32 v181, v181, v14, v15
    v_fma_f32 v183, v183, v14, v15
    v_mfma_f32_32x32x16_bf16 v[128:143], a[36:39], v[52:55], v[128:143]
    ds_read_b64_tr_b16 a[12:13], v11 offset:36864
    v_cvt_pk_bf16_f32 v56, v176, v177
    v_cvt_pk_bf16_f32 v57, v178, v179
    v_cvt_pk_bf16_f32 v58, v180, v181
    ds_read_b64_tr_b16 a[14:15], v11 offset:38400
    v_cvt_pk_bf16_f32 v59, v182, v183
    s_mov_b32 s31, 1232896
    v_mfma_f32_32x32x16_bf16 v[144:159], a[40:43], v[52:55], v[144:159]
    s_add_u32 m0, s30, 24576
    ds_read_b64_tr_b16 a[16:17], v11 offset:36928
    s_nop 0
    buffer_load_dwordx4 v200, s[36:39], s31 offen lds
    ds_read_b64_tr_b16 a[18:19], v11 offset:38464
    s_mov_b32 s31, 1232896
    s_add_u32 m0, s30, 25600
    v_mfma_f32_32x32x16_bf16 v[160:175], a[44:47], v[52:55], v[160:175]
    s_nop 0
    ds_read_b64_tr_b16 a[20:21], v11 offset:36992
    buffer_load_dwordx4 v201, s[36:39], s31 offen lds
    s_mov_b32 s31, 1232896
    s_add_u32 m0, s30, 26624
    ds_read_b64_tr_b16 a[22:23], v11 offset:38528
    s_nop 0
    buffer_load_dwordx4 v202, s[36:39], s31 offen lds
    s_waitcnt lgkmcnt(0)
    v_mfma_f32_32x32x16_bf16 v[80:95], a[0:3], v[56:59], v[80:95]
    ds_read_b64_tr_b16 a[24:25], v11 offset:30720
    v_lshlrev_b32 v176, 16, v60
    v_lshlrev_b32 v178, 16, v61
    ds_read_b64_tr_b16 a[26:27], v11 offset:32256
    v_lshlrev_b32 v180, 16, v62
    v_mfma_f32_32x32x16_bf16 v[96:111], a[4:7], v[56:59], v[96:111]
    v_lshlrev_b32 v182, 16, v63
    ds_read_b64_tr_b16 a[28:29], v11 offset:30784
    v_and_b32 v177, 0xffff0000, v60
    ds_read_b64_tr_b16 a[30:31], v11 offset:32320
    v_and_b32 v179, 0xffff0000, v61
    v_mfma_f32_32x32x16_bf16 v[112:127], a[8:11], v[56:59], v[112:127]
    v_and_b32 v181, 0xffff0000, v62
    ds_read_b64_tr_b16 a[32:33], v11 offset:30848
    v_and_b32 v183, 0xffff0000, v63
    v_fma_f32 v176, v176, v14, v15
    ds_read_b64_tr_b16 a[34:35], v11 offset:32384
    v_fma_f32 v178, v178, v14, v15
    v_mfma_f32_32x32x16_bf16 v[128:143], a[12:15], v[56:59], v[128:143]
    ds_read_b64_tr_b16 a[36:37], v11 offset:43008
    v_fma_f32 v180, v180, v14, v15
    v_fma_f32 v182, v182, v14, v15
    ds_read_b64_tr_b16 a[38:39], v11 offset:44544
    v_fma_f32 v177, v177, v14, v15
    v_mfma_f32_32x32x16_bf16 v[144:159], a[16:19], v[56:59], v[144:159]
    v_fma_f32 v179, v179, v14, v15
    ds_read_b64_tr_b16 a[40:41], v11 offset:43072
    v_fma_f32 v181, v181, v14, v15
    ds_read_b64_tr_b16 a[42:43], v11 offset:44608
    v_fma_f32 v183, v183, v14, v15
    v_mfma_f32_32x32x16_bf16 v[160:175], a[20:23], v[56:59], v[160:175]
    v_cvt_pk_bf16_f32 v60, v176, v177
    ds_read_b64_tr_b16 a[44:45], v11 offset:43136
    v_cvt_pk_bf16_f32 v61, v178, v179
    v_cvt_pk_bf16_f32 v62, v180, v181
    ds_read_b64_tr_b16 a[46:47], v11 offset:44672
    v_cvt_pk_bf16_f32 v63, v182, v183
    s_waitcnt lgkmcnt(0)
    s_waitcnt vmcnt(3)
    s_barrier
    v_mfma_f32_32x32x16_bf16 v[80:95], a[24:27], v[60:63], v[80:95]
    ds_read_b64_tr_b16 a[0:1], v12 offset:0
    v_lshlrev_b32 v176, 16, v64
    v_lshlrev_b32 v178, 16, v65
    ds_read_b64_tr_b16 a[2:3], v12 offset:1536
    v_lshlrev_b32 v180, 16, v66
    v_mfma_f32_32x32x16_bf16 v[96:111], a[28:31], v[60:63], v[96:111]
    v_lshlrev_b32 v182, 16, v67
    ds_read_b64_tr_b16 a[4:5], v12 offset:64
    v_and_b32 v177, 0xffff0000, v64
    ds_read_b64_tr_b16 a[6:7], v12 offset:1600
    v_and_b32 v179, 0xffff0000, v65
    v_mfma_f32_32x32x16_bf16 v[112:127], a[32:35], v[60:63], v[112:127]
    v_and_b32 v181, 0xffff0000, v66
    ds_read_b64_tr_b16 a[8:9], v12 offset:128
    v_and_b32 v183, 0xffff0000, v67
    v_fma_f32 v176, v176, v14, v15
    ds_read_b64_tr_b16 a[10:11], v12 offset:1664
    v_fma_f32 v178, v178, v14, v15
    v_mfma_f32_32x32x16_bf16 v[128:143], a[36:39], v[60:63], v[128:143]
    ds_read_b64_tr_b16 a[12:13], v12 offset:12288
    v_fma_f32 v180, v180, v14, v15
    v_fma_f32 v182, v182, v14, v15
    ds_read_b64_tr_b16 a[14:15], v12 offset:13824
    v_fma_f32 v177, v177, v14, v15
    v_mfma_f32_32x32x16_bf16 v[144:159], a[40:43], v[60:63], v[144:159]
    v_fma_f32 v179, v179, v14, v15
    ds_read_b64_tr_b16 a[16:17], v12 offset:12352
    v_fma_f32 v181, v181, v14, v15
    ds_read_b64_tr_b16 a[18:19], v12 offset:13888
    v_fma_f32 v183, v183, v14, v15
    v_mfma_f32_32x32x16_bf16 v[160:175], a[44:47], v[60:63], v[160:175]
    v_cvt_pk_bf16_f32 v64, v176, v177
    ds_read_b64_tr_b16 a[20:21], v12 offset:12416
    v_cvt_pk_bf16_f32 v65, v178, v179
    v_cvt_pk_bf16_f32 v66, v180, v181
    ds_read_b64_tr_b16 a[22:23], v12 offset:13952
    v_cvt_pk_bf16_f32 v67, v182, v183
    s_waitcnt lgkmcnt(0)
    v_mfma_f32_32x32x16_bf16 v[80:95], a[0:3], v[64:67], v[80:95]
    ds_read_b64_tr_b16 a[24:25], v12 offset:6144
    v_lshlrev_b32 v176, 16, v68
    v_lshlrev_b32 v178, 16, v69
    ds_read_b64_tr_b16 a[26:27], v12 offset:7680
    v_lshlrev_b32 v180, 16, v70
    v_mfma_f32_32x32x16_bf16 v[96:111], a[4:7], v[64:67], v[96:111]
    v_lshlrev_b32 v182, 16, v71
    ds_read_b64_tr_b16 a[28:29], v12 offset:6208
    v_and_b32 v177, 0xffff0000, v68
    ds_read_b64_tr_b16 a[30:31], v12 offset:7744
    v_and_b32 v179, 0xffff0000, v69
    v_mfma_f32_32x32x16_bf16 v[112:127], a[8:11], v[64:67], v[112:127]
    v_and_b32 v181, 0xffff0000, v70
    ds_read_b64_tr_b16 a[32:33], v12 offset:6272
    v_and_b32 v183, 0xffff0000, v71
    v_fma_f32 v176, v176, v14, v15
    ds_read_b64_tr_b16 a[34:35], v12 offset:7808
    v_fma_f32 v178, v178, v14, v15
    v_mfma_f32_32x32x16_bf16 v[128:143], a[12:15], v[64:67], v[128:143]
    ds_read_b64_tr_b16 a[36:37], v12 offset:18432
    v_fma_f32 v180, v180, v14, v15
    v_fma_f32 v182, v182, v14, v15
    ds_read_b64_tr_b16 a[38:39], v12 offset:19968
    v_fma_f32 v177, v177, v14, v15
    v_mfma_f32_32x32x16_bf16 v[144:159], a[16:19], v[64:67], v[144:159]
    v_fma_f32 v179, v179, v14, v15
    ds_read_b64_tr_b16 a[40:41], v12 offset:18496
    v_fma_f32 v181, v181, v14, v15
    ds_read_b64_tr_b16 a[42:43], v12 offset:20032
    v_fma_f32 v183, v183, v14, v15
    v_mfma_f32_32x32x16_bf16 v[160:175], a[20:23], v[64:67], v[160:175]
    v_cvt_pk_bf16_f32 v68, v176, v177
    ds_read_b64_tr_b16 a[44:45], v12 offset:18560
    v_cvt_pk_bf16_f32 v69, v178, v179
    v_cvt_pk_bf16_f32 v70, v180, v181
    ds_read_b64_tr_b16 a[46:47], v12 offset:20096
    v_cvt_pk_bf16_f32 v71, v182, v183
    s_waitcnt lgkmcnt(0)
    s_waitcnt vmcnt(0)
    s_barrier
    v_mfma_f32_32x32x16_bf16 v[80:95], a[24:27], v[68:71], v[80:95]
    ds_read_b64_tr_b16 a[0:1], v12 offset:24576
    v_lshlrev_b32 v176, 16, v72
    v_lshlrev_b32 v178, 16, v73
    ds_read_b64_tr_b16 a[2:3], v12 offset:26112
    v_lshlrev_b32 v180, 16, v74
    v_mfma_f32_32x32x16_bf16 v[96:111], a[28:31], v[68:71], v[96:111]
    v_lshlrev_b32 v182, 16, v75
    ds_read_b64_tr_b16 a[4:5], v12 offset:24640
    v_and_b32 v177, 0xffff0000, v72
    ds_read_b64_tr_b16 a[6:7], v12 offset:26176
    v_and_b32 v179, 0xffff0000, v73
    v_mfma_f32_32x32x16_bf16 v[112:127], a[32:35], v[68:71], v[112:127]
    v_and_b32 v181, 0xffff0000, v74
    ds_read_b64_tr_b16 a[8:9], v12 offset:24704
    v_and_b32 v183, 0xffff0000, v75
    v_fma_f32 v176, v176, v14, v15
    ds_read_b64_tr_b16 a[10:11], v12 offset:26240
    v_fma_f32 v178, v178, v14, v15
    v_mfma_f32_32x32x16_bf16 v[128:143], a[36:39], v[68:71], v[128:143]
    ds_read_b64_tr_b16 a[12:13], v12 offset:36864
    v_fma_f32 v180, v180, v14, v15
    v_fma_f32 v182, v182, v14, v15
    ds_read_b64_tr_b16 a[14:15], v12 offset:38400
    v_fma_f32 v177, v177, v14, v15
    v_mfma_f32_32x32x16_bf16 v[144:159], a[40:43], v[68:71], v[144:159]
    v_fma_f32 v179, v179, v14, v15
    ds_read_b64_tr_b16 a[16:17], v12 offset:36928
    v_fma_f32 v181, v181, v14, v15
    ds_read_b64_tr_b16 a[18:19], v12 offset:38464
    v_fma_f32 v183, v183, v14, v15
    v_mfma_f32_32x32x16_bf16 v[160:175], a[44:47], v[68:71], v[160:175]
    v_cvt_pk_bf16_f32 v72, v176, v177
    ds_read_b64_tr_b16 a[20:21], v12 offset:36992
    v_cvt_pk_bf16_f32 v73, v178, v179
    v_cvt_pk_bf16_f32 v74, v180, v181
    ds_read_b64_tr_b16 a[22:23], v12 offset:38528
    v_cvt_pk_bf16_f32 v75, v182, v183
    s_waitcnt lgkmcnt(0)
    v_mfma_f32_32x32x16_bf16 v[80:95], a[0:3], v[72:75], v[80:95]
    ds_read_b64_tr_b16 a[24:25], v12 offset:30720
    v_lshlrev_b32 v176, 16, v76
    v_lshlrev_b32 v178, 16, v77
    ds_read_b64_tr_b16 a[26:27], v12 offset:32256
    v_lshlrev_b32 v180, 16, v78
    v_mfma_f32_32x32x16_bf16 v[96:111], a[4:7], v[72:75], v[96:111]
    v_lshlrev_b32 v182, 16, v79
    ds_read_b64_tr_b16 a[28:29], v12 offset:30784
    v_and_b32 v177, 0xffff0000, v76
    ds_read_b64_tr_b16 a[30:31], v12 offset:32320
    v_and_b32 v179, 0xffff0000, v77
    v_mfma_f32_32x32x16_bf16 v[112:127], a[8:11], v[72:75], v[112:127]
    v_and_b32 v181, 0xffff0000, v78
    ds_read_b64_tr_b16 a[32:33], v12 offset:30848
    v_and_b32 v183, 0xffff0000, v79
    v_fma_f32 v176, v176, v14, v15
    ds_read_b64_tr_b16 a[34:35], v12 offset:32384
    v_fma_f32 v178, v178, v14, v15
    v_mfma_f32_32x32x16_bf16 v[128:143], a[12:15], v[72:75], v[128:143]
    ds_read_b64_tr_b16 a[36:37], v12 offset:43008
    v_fma_f32 v180, v180, v14, v15
    v_fma_f32 v182, v182, v14, v15
    ds_read_b64_tr_b16 a[38:39], v12 offset:44544
    v_fma_f32 v177, v177, v14, v15
    v_mfma_f32_32x32x16_bf16 v[144:159], a[16:19], v[72:75], v[144:159]
    v_fma_f32 v179, v179, v14, v15
    ds_read_b64_tr_b16 a[40:41], v12 offset:43072
    v_fma_f32 v181, v181, v14, v15
    ds_read_b64_tr_b16 a[42:43], v12 offset:44608
    v_fma_f32 v183, v183, v14, v15
    v_mfma_f32_32x32x16_bf16 v[160:175], a[20:23], v[72:75], v[160:175]
    v_cvt_pk_bf16_f32 v76, v176, v177
    ds_read_b64_tr_b16 a[44:45], v12 offset:43136
    v_cvt_pk_bf16_f32 v77, v178, v179
    v_cvt_pk_bf16_f32 v78, v180, v181
    ds_read_b64_tr_b16 a[46:47], v12 offset:44672
    v_cvt_pk_bf16_f32 v79, v182, v183
    s_waitcnt lgkmcnt(0)
    v_mfma_f32_32x32x16_bf16 v[80:95], a[24:27], v[76:79], v[80:95]
    v_mfma_f32_32x32x16_bf16 v[96:111], a[28:31], v[76:79], v[96:111]
    v_mfma_f32_32x32x16_bf16 v[112:127], a[32:35], v[76:79], v[112:127]
    v_mfma_f32_32x32x16_bf16 v[128:143], a[36:39], v[76:79], v[128:143]
    v_mfma_f32_32x32x16_bf16 v[144:159], a[40:43], v[76:79], v[144:159]
    v_mfma_f32_32x32x16_bf16 v[160:175], a[44:47], v[76:79], v[160:175]
    s_mul_i32 s28, s2, 5888
    v_lshlrev_b32 v9, 4, v0
    v_add_u32 v9, s28, v9
    buffer_load_dwordx4 v[200:203], v9, s[44:47], 0 offen
    s_nop 7
    s_nop 7
    s_barrier
    s_lshl_b32 s28, s24, 14
    v_lshlrev_b32 v8, 4, v1
    v_add_u32 v9, s28, v8
    s_xor_b32 s28, s28, 0x10000
    v_add_u32 v8, s28, v8
    s_mul_i32 s28, s27, 88064
    s_mul_i32 s29, s26, 6144
    s_add_u32 s28, s28, s29
    s_add_u32 s28, s28, 0x600000
    v_lshlrev_b32 v10, 4, v1
    v_add_u32 v10, s28, v10
    s_cmp_eq_u32 s35, 0
    s_cbranch_scc0 K3_KP1
    ds_write_b128 v9, v[112:115] offset:0
    ds_write_b128 v9, v[116:119] offset:1024
    ds_write_b128 v9, v[120:123] offset:2048
    ds_write_b128 v9, v[124:127] offset:3072
    ds_write_b128 v9, v[160:163] offset:4096
    ds_write_b128 v9, v[164:167] offset:5120
    ds_write_b128 v9, v[168:171] offset:6144
    ds_write_b128 v9, v[172:175] offset:7168
    s_waitcnt lgkmcnt(0)
    s_barrier
    ds_read_b128 v[16:19], v8 offset:0
    ds_read_b128 v[20:23], v8 offset:1024
    ds_read_b128 v[24:27], v8 offset:2048
    ds_read_b128 v[28:31], v8 offset:3072
    ds_read_b128 v[32:35], v8 offset:4096
    ds_read_b128 v[36:39], v8 offset:5120
    ds_read_b128 v[40:43], v8 offset:6144
    ds_read_b128 v[44:47], v8 offset:7168
    ds_read_b128 v[48:51], v8 offset:8192
    ds_read_b128 v[52:55], v8 offset:9216
    ds_read_b128 v[56:59], v8 offset:10240
    ds_read_b128 v[60:63], v8 offset:11264
    ds_read_b128 v[64:67], v8 offset:12288
    ds_read_b128 v[68:71], v8 offset:13312
    ds_read_b128 v[72:75], v8 offset:14336
    ds_read_b128 v[76:79], v8 offset:15360
    s_waitcnt lgkmcnt(12)
    v_add_f32 v80, v80, v16
    v_add_f32 v81, v81, v17
    v_add_f32 v82, v82, v18
    v_add_f32 v83, v83, v19
    v_add_f32 v84, v84, v20
    v_add_f32 v85, v85, v21
    v_add_f32 v86, v86, v22
    v_add_f32 v87, v87, v23
    v_add_f32 v88, v88, v24
    v_add_f32 v89, v89, v25
    v_add_f32 v90, v90, v26
    v_add_f32 v91, v91, v27
    v_add_f32 v92, v92, v28
    v_add_f32 v93, v93, v29
    v_add_f32 v94, v94, v30
    v_add_f32 v95, v95, v31
    s_waitcnt lgkmcnt(8)
    v_add_f32 v128, v128, v32
    v_add_f32 v129, v129, v33
    v_add_f32 v130, v130, v34
    v_add_f32 v131, v131, v35
    v_add_f32 v132, v132, v36
    v_add_f32 v133, v133, v37
    v_add_f32 v134, v134, v38
    v_add_f32 v135, v135, v39
    v_add_f32 v136, v136, v40
    v_add_f32 v137, v137, v41
    v_add_f32 v138, v138, v42
    v_add_f32 v139, v139, v43
    v_add_f32 v140, v140, v44
    v_add_f32 v141, v141, v45
    v_add_f32 v142, v142, v46
    v_add_f32 v143, v143, v47
    s_waitcnt lgkmcnt(4)
    v_add_f32 v96, v96, v48
    v_add_f32 v97, v97, v49
    v_add_f32 v98, v98, v50
    v_add_f32 v99, v99, v51
    v_add_f32 v100, v100, v52
    v_add_f32 v101, v101, v53
    v_add_f32 v102, v102, v54
    v_add_f32 v103, v103, v55
    v_add_f32 v104, v104, v56
    v_add_f32 v105, v105, v57
    v_add_f32 v106, v106, v58
    v_add_f32 v107, v107, v59
    v_add_f32 v108, v108, v60
    v_add_f32 v109, v109, v61
    v_add_f32 v110, v110, v62
    v_add_f32 v111, v111, v63
    s_waitcnt lgkmcnt(0)
    v_add_f32 v144, v144, v64
    v_add_f32 v145, v145, v65
    v_add_f32 v146, v146, v66
    v_add_f32 v147, v147, v67
    v_add_f32 v148, v148, v68
    v_add_f32 v149, v149, v69
    v_add_f32 v150, v150, v70
    v_add_f32 v151, v151, v71
    v_add_f32 v152, v152, v72
    v_add_f32 v153, v153, v73
    v_add_f32 v154, v154, v74
    v_add_f32 v155, v155, v75
    v_add_f32 v156, v156, v76
    v_add_f32 v157, v157, v77
    v_add_f32 v158, v158, v78
    v_add_f32 v159, v159, v79
    v_mul_f32 v80, v80, v128
    v_mul_f32 v81, v81, v129
    v_mul_f32 v82, v82, v130
    v_mul_f32 v83, v83, v131
    v_mul_f32 v84, v84, v132
    v_mul_f32 v85, v85, v133
    v_mul_f32 v86, v86, v134
    v_mul_f32 v87, v87, v135
    v_mul_f32 v88, v88, v136
    v_mul_f32 v89, v89, v137
    v_mul_f32 v90, v90, v138
    v_mul_f32 v91, v91, v139
    v_mul_f32 v92, v92, v140
    v_mul_f32 v93, v93, v141
    v_mul_f32 v94, v94, v142
    v_mul_f32 v95, v95, v143
    v_cvt_pk_bf16_f32 v128, v80, v81
    v_cvt_pk_bf16_f32 v129, v82, v83
    v_cvt_pk_bf16_f32 v130, v84, v85
    v_cvt_pk_bf16_f32 v131, v86, v87
    v_cvt_pk_bf16_f32 v132, v88, v89
    v_cvt_pk_bf16_f32 v133, v90, v91
    v_cvt_pk_bf16_f32 v134, v92, v93
    v_cvt_pk_bf16_f32 v135, v94, v95
    s_movk_i32 s31, 0
    buffer_store_dwordx4 v[128:131], v10, s[20:23], s31 offen offset:0 sc1
    buffer_store_dwordx4 v[132:135], v10, s[20:23], s31 offen offset:1024 sc1
    s_cmp_ge_u32 s26, 14
    s_cbranch_scc1 K3_END
    v_mul_f32 v96, v96, v144
    v_mul_f32 v97, v97, v145
    v_mul_f32 v98, v98, v146
    v_mul_f32 v99, v99, v147
    v_mul_f32 v100, v100, v148
    v_mul_f32 v101, v101, v149
    v_mul_f32 v102, v102, v150
    v_mul_f32 v103, v103, v151
    v_mul_f32 v104, v104, v152
    v_mul_f32 v105, v105, v153
    v_mul_f32 v106, v106, v154
    v_mul_f32 v107, v107, v155
    v_mul_f32 v108, v108, v156
    v_mul_f32 v109, v109, v157
    v_mul_f32 v110, v110, v158
    v_mul_f32 v111, v111, v159
    v_cvt_pk_bf16_f32 v144, v96, v97
    v_cvt_pk_bf16_f32 v145, v98, v99
    v_cvt_pk_bf16_f32 v146, v100, v101
    v_cvt_pk_bf16_f32 v147, v102, v103
    v_cvt_pk_bf16_f32 v148, v104, v105
    v_cvt_pk_bf16_f32 v149, v106, v107
    v_cvt_pk_bf16_f32 v150, v108, v109
    v_cvt_pk_bf16_f32 v151, v110, v111
    s_movk_i32 s31, 2048
    buffer_store_dwordx4 v[144:147], v10, s[20:23], s31 offen offset:0 sc1
    buffer_store_dwordx4 v[148:151], v10, s[20:23], s31 offen offset:1024 sc1
    s_branch K3_END
K3_KP1:
    ds_write_b128 v9, v[80:83] offset:0
    ds_write_b128 v9, v[84:87] offset:1024
    ds_write_b128 v9, v[88:91] offset:2048
    ds_write_b128 v9, v[92:95] offset:3072
    ds_write_b128 v9, v[128:131] offset:4096
    ds_write_b128 v9, v[132:135] offset:5120
    ds_write_b128 v9, v[136:139] offset:6144
    ds_write_b128 v9, v[140:143] offset:7168
    ds_write_b128 v9, v[96:99] offset:8192
    ds_write_b128 v9, v[100:103] offset:9216
    ds_write_b128 v9, v[104:107] offset:10240
    ds_write_b128 v9, v[108:111] offset:11264
    ds_write_b128 v9, v[144:147] offset:12288
    ds_write_b128 v9, v[148:151] offset:13312
    ds_write_b128 v9, v[152:155] offset:14336
    ds_write_b128 v9, v[156:159] offset:15360
    s_waitcnt lgkmcnt(0)
    s_barrier
    s_cmp_ge_u32 s26, 14
    s_cbranch_scc1 K3_END
    ds_read_b128 v[16:19], v8 offset:0
    ds_read_b128 v[20:23], v8 offset:1024
    ds_read_b128 v[24:27], v8 offset:2048
    ds_read_b128 v[28:31], v8 offset:3072
    ds_read_b128 v[32:35], v8 offset:4096
    ds_read_b128 v[36:39], v8 offset:5120
    ds_read_b128 v[40:43], v8 offset:6144
    ds_read_b128 v[44:47], v8 offset:7168
    s_waitcnt lgkmcnt(4)
    v_add_f32 v112, v112, v16
    v_add_f32 v113, v113, v17
    v_add_f32 v114, v114, v18
    v_add_f32 v115, v115, v19
    v_add_f32 v116, v116, v20
    v_add_f32 v117, v117, v21
    v_add_f32 v118, v118, v22
    v_add_f32 v119, v119, v23
    v_add_f32 v120, v120, v24
    v_add_f32 v121, v121, v25
    v_add_f32 v122, v122, v26
    v_add_f32 v123, v123, v27
    v_add_f32 v124, v124, v28
    v_add_f32 v125, v125, v29
    v_add_f32 v126, v126, v30
    v_add_f32 v127, v127, v31
    s_waitcnt lgkmcnt(0)
    v_add_f32 v160, v160, v32
    v_add_f32 v161, v161, v33
    v_add_f32 v162, v162, v34
    v_add_f32 v163, v163, v35
    v_add_f32 v164, v164, v36
    v_add_f32 v165, v165, v37
    v_add_f32 v166, v166, v38
    v_add_f32 v167, v167, v39
    v_add_f32 v168, v168, v40
    v_add_f32 v169, v169, v41
    v_add_f32 v170, v170, v42
    v_add_f32 v171, v171, v43
    v_add_f32 v172, v172, v44
    v_add_f32 v173, v173, v45
    v_add_f32 v174, v174, v46
    v_add_f32 v175, v175, v47
    v_mul_f32 v112, v112, v160
    v_mul_f32 v113, v113, v161
    v_mul_f32 v114, v114, v162
    v_mul_f32 v115, v115, v163
    v_mul_f32 v116, v116, v164
    v_mul_f32 v117, v117, v165
    v_mul_f32 v118, v118, v166
    v_mul_f32 v119, v119, v167
    v_mul_f32 v120, v120, v168
    v_mul_f32 v121, v121, v169
    v_mul_f32 v122, v122, v170
    v_mul_f32 v123, v123, v171
    v_mul_f32 v124, v124, v172
    v_mul_f32 v125, v125, v173
    v_mul_f32 v126, v126, v174
    v_mul_f32 v127, v127, v175
    v_cvt_pk_bf16_f32 v160, v112, v113
    v_cvt_pk_bf16_f32 v161, v114, v115
    v_cvt_pk_bf16_f32 v162, v116, v117
    v_cvt_pk_bf16_f32 v163, v118, v119
    v_cvt_pk_bf16_f32 v164, v120, v121
    v_cvt_pk_bf16_f32 v165, v122, v123
    v_cvt_pk_bf16_f32 v166, v124, v125
    v_cvt_pk_bf16_f32 v167, v126, v127
    s_movk_i32 s31, 4096
    buffer_store_dwordx4 v[160:163], v10, s[20:23], s31 offen offset:0 sc1
    buffer_store_dwordx4 v[164:167], v10, s[20:23], s31 offen offset:1024 sc1
K3_END:
    s_endpgm
.p2align 8
.globl sequential_preLN__linear_attn_block__glu_gated_bilinear__prompt_kernel
.type sequential_preLN__linear_attn_block__glu_gated_bilinear__prompt_kernel,@function
sequential_preLN__linear_attn_block__glu_gated_bilinear__prompt_kernel:
    s_cmp_ge_u32 s2, 256
    s_cbranch_scc1 K4_END
    s_load_dwordx2 s[4:5], s[0:1], 48
    s_load_dwordx2 s[6:7], s[0:1], 56
    s_load_dwordx2 s[8:9], s[0:1], 72
    v_and_b32 v1, 63, v0
    v_lshrrev_b32 v4, 6, v0
    s_nop 0
    v_readfirstlane_b32 s24, v4
    v_and_b32 v2, 31, v1
    v_lshrrev_b32 v3, 5, v1
    s_and_b32 s34, s24, 3
    s_lshr_b32 s35, s24, 2
    s_and_b32 s25, s2, 7
    s_lshl_b32 s25, s25, 2
    s_bfe_u32 s26, s2, 0x20003
    s_or_b32 s25, s25, s26
    s_lshr_b32 s26, s2, 5
    s_and_b32 s32, s24, 1
    s_bfe_u32 s33, s24, 0x10001
    s_waitcnt lgkmcnt(0)
    s_mov_b32 s12, s4
    s_mov_b32 s13, s5
    s_mov_b32 s14, 0x158000
    s_mov_b32 s15, 0x00020000
    s_mov_b32 s16, s6
    s_mov_b32 s17, s7
    s_mov_b32 s18, 0x200000
    s_mov_b32 s19, 0x00020000
    s_mov_b32 s20, s8
    s_mov_b32 s21, s9
    s_mov_b32 s22, 0xb60000
    s_mov_b32 s23, 0x00020000
    s_lshl_b32 s27, s25, 1
    s_add_u32 s27, s27, s32
    s_lshl_b32 s28, s27, 15
    s_lshl_b32 s29, s26, 12
    s_add_u32 s28, s28, s29
    s_lshl_b32 s29, s33, 11
    s_add_u32 s28, s28, s29
    s_lshl_b32 s29, s35, 10
    s_add_u32 s28, s28, s29
    s_add_u32 s28, s28, 0x400000
    v_lshlrev_b32 v14, 4, v1
    v_add_u32 v14, s28, v14
    buffer_load_dwordx4 v[32:35], v14, s[20:23], 0 offen
    s_mul_i32 s28, s27, 88064
    s_lshr_b32 s29, s24, 1
    s_lshl_b32 s29, s29, 11
    s_add_u32 s28, s28, s29
    s_add_u32 s28, s28, 0x600000
    v_lshlrev_b32 v15, 4, v1
    v_add_u32 v15, s28, v15
    s_lshl_b32 s36, s32, 13
    s_add_u32 s36, s36, s29
    v_lshrrev_b32 v10, 3, v1
    v_and_b32 v11, 7, v1
    v_bfe_u32 v8, v10, 1, 1
    v_lshlrev_b32 v8, 2, v8
    v_xor_b32 v11, v11, v8
    s_lshl_b32 s28, s24, 4
    v_add_u32 v10, s28, v10
    v_lshlrev_b32 v10, 10, v10
    v_lshl_add_u32 v10, v11, 4, v10
    s_lshl_b32 s29, s26, 7
    v_add_u32 v10, s29, v10
    s_lshl_b32 s30, s24, 11
    s_add_u32 s30, s30, 16384
    s_mov_b32 s31, 0
    s_add_u32 m0, s36, 0
    s_nop 0
    buffer_load_dwordx4 v15, s[20:23], s31 offen lds
    s_mov_b32 s31, 0
    s_add_u32 m0, s30, 0
    s_nop 0
    buffer_load_dwordx4 v10, s[12:15], s31 offen lds
    s_mov_b32 s31, 1024
    s_add_u32 m0, s36, 1024
    s_nop 0
    buffer_load_dwordx4 v15, s[20:23], s31 offen lds
    s_mov_b32 s31, 8192
    s_add_u32 m0, s30, 1024
    s_nop 0
    buffer_load_dwordx4 v10, s[12:15], s31 offen lds
    s_mov_b32 s31, 8192
    s_add_u32 m0, s36, 32768
    s_nop 0
    buffer_load_dwordx4 v15, s[20:23], s31 offen lds
    s_mov_b32 s31, 131072
    s_add_u32 m0, s30, 32768
    s_nop 0
    buffer_load_dwordx4 v10, s[12:15], s31 offen lds
    s_mov_b32 s31, 9216
    s_add_u32 m0, s36, 33792
    s_nop 0
    buffer_load_dwordx4 v15, s[20:23], s31 offen lds
    s_mov_b32 s31, 139264
    s_add_u32 m0, s30, 33792
    s_nop 0
    buffer_load_dwordx4 v10, s[12:15], s31 offen lds
    s_mov_b32 s31, 16384
    s_add_u32 m0, s36, 65536
    s_nop 0
    buffer_load_dwordx4 v15, s[20:23], s31 offen lds
    s_mov_b32 s31, 262144
    s_add_u32 m0, s30, 65536
    s_nop 0
    buffer_load_dwordx4 v10, s[12:15], s31 offen lds
    s_mov_b32 s31, 17408
    s_add_u32 m0, s36, 66560
    s_nop 0
    buffer_load_dwordx4 v15, s[20:23], s31 offen lds
    s_mov_b32 s31, 270336
    s_add_u32 m0, s30, 66560
    s_nop 0
    buffer_load_dwordx4 v10, s[12:15], s31 offen lds
    v_bfe_u32 v5, v1, 2, 2
    v_and_b32 v6, 3, v1
    v_bfe_u32 v7, v1, 4, 1
    v_lshl_add_u32 v12, v3, 2, v5
    v_lshlrev_b32 v12, 7, v12
    v_lshrrev_b32 v8, 1, v5
    v_xor_b32 v8, s33, v8
    v_lshl_add_u32 v12, v8, 6, v12
    v_lshl_add_u32 v12, v7, 5, v12
    v_lshl_add_u32 v12, v6, 3, v12
    s_lshl_b32 s28, s35, 11
    s_add_u32 s28, s28, 0x4000
    v_add_u32 v12, s28, v12
    v_add_u32 v13, 0x10000, v12
    s_lshl_b32 s28, s32, 13
    s_lshl_b32 s29, s35, 10
    s_add_u32 s28, s28, s29
    v_lshlrev_b32 v4, 4, v1
    v_add_u32 v4, s28, v4
    v_add_u32 v9, 0x10000, v4
    s_waitcnt vmcnt(8)
    s_barrier
    ds_read_b128 a[0:3], v4 offset:0
    ds_read_b64_tr_b16 a[12:13], v12 offset:0
    ds_read_b64_tr_b16 a[14:15], v12 offset:1024
    ds_read_b128 a[4:7], v4 offset:2048
    ds_read_b64_tr_b16 a[16:17], v12 offset:4096
    ds_read_b64_tr_b16 a[18:19], v12 offset:5120
    s_waitcnt lgkmcnt(3)
    v_mfma_f32_32x32x16_bf16 v[16:31], a[12:15], a[0:3], 0
    ds_read_b128 a[8:11], v4 offset:4096
    ds_read_b64_tr_b16 a[20:21], v12 offset:8192
    ds_read_b64_tr_b16 a[22:23], v12 offset:9216
    s_waitcnt lgkmcnt(3)
    v_mfma_f32_32x32x16_bf16 v[16:31], a[16:19], a[4:7], v[16:31]
    ds_read_b128 a[0:3], v4 offset:6144
    ds_read_b64_tr_b16 a[12:13], v12 offset:12288
    ds_read_b64_tr_b16 a[14:15], v12 offset:13312
    s_waitcnt lgkmcnt(3)
    s_waitcnt vmcnt(4)
    s_barrier
    v_mfma_f32_32x32x16_bf16 v[16:31], a[20:23], a[8:11], v[16:31]
    ds_read_b128 a[4:7], v4 offset:32768
    ds_read_b64_tr_b16 a[16:17], v12 offset:32768
    ds_read_b64_tr_b16 a[18:19], v12 offset:33792
    s_mov_b32 s31, 24576
    s_add_u32 m0, s36, 98304
    s_nop 0
    buffer_load_dwordx4 v15, s[20:23], s31 offen lds
    s_mov_b32 s31, 393216
    s_add_u32 m0, s30, 98304
    s_nop 0
    buffer_load_dwordx4 v10, s[12:15], s31 offen lds
    s_waitcnt lgkmcnt(3)
    v_mfma_f32_32x32x16_bf16 v[16:31], a[12:15], a[0:3], v[16:31]
    ds_read_b128 a[8:11], v4 offset:34816
    ds_read_b64_tr_b16 a[20:21], v12 offset:36864
    ds_read_b64_tr_b16 a[22:23], v12 offset:37888
    s_mov_b32 s31, 25600
    s_add_u32 m0, s36, 99328
    s_nop 0
    buffer_load_dwordx4 v15, s[20:23], s31 offen lds
    s_mov_b32 s31, 401408
    s_add_u32 m0, s30, 99328
    s_nop 0
    buffer_load_dwordx4 v10, s[12:15], s31 offen lds
    s_waitcnt lgkmcnt(3)
    v_mfma_f32_32x32x16_bf16 v[16:31], a[16:19], a[4:7], v[16:31]
    ds_read_b128 a[0:3], v4 offset:36864
    ds_read_b64_tr_b16 a[12:13], v12 offset:40960
    ds_read_b64_tr_b16 a[14:15], v12 offset:41984
    s_waitcnt lgkmcnt(3)
    v_mfma_f32_32x32x16_bf16 v[16:31], a[20:23], a[8:11], v[16:31]
    ds_read_b128 a[4:7], v4 offset:38912
    ds_read_b64_tr_b16 a[16:17], v12 offset:45056
    ds_read_b64_tr_b16 a[18:19], v12 offset:46080
    s_waitcnt lgkmcnt(3)
    s_waitcnt vmcnt(4)
    s_barrier
    v_mfma_f32_32x32x16_bf16 v[16:31], a[12:15], a[0:3], v[16:31]
    ds_read_b128 a[8:11], v9 offset:0
    ds_read_b64_tr_b16 a[20:21], v13 offset:0
    ds_read_b64_tr_b16 a[22:23], v13 offset:1024
    s_mov_b32 s31, 32768
    s_add_u32 m0, s36, 0
    s_nop 0
    buffer_load_dwordx4 v15, s[20:23], s31 offen lds
    s_mov_b32 s31, 524288
    s_add_u32 m0, s30, 0
    s_nop 0
    buffer_load_dwordx4 v10, s[12:15], s31 offen lds
    s_waitcnt lgkmcnt(3)
    v_mfma_f32_32x32x16_bf16 v[16:31], a[16:19], a[4:7], v[16:31]
    ds_read_b128 a[0:3], v9 offset:2048
    ds_read_b64_tr_b16 a[12:13], v13 offset:4096
    ds_read_b64_tr_b16 a[14:15], v13 offset:5120
    s_mov_b32 s31, 33792
    s_add_u32 m0, s36, 1024
    s_nop 0
    buffer_load_dwordx4 v15, s[20:23], s31 offen lds
    s_mov_b32 s31, 532480
    s_add_u32 m0, s30, 1024
    s_nop 0
    buffer_load_dwordx4 v10, s[12:15], s31 offen lds
    s_waitcnt lgkmcnt(3)
    v_mfma_f32_32x32x16_bf16 v[16:31], a[20:23], a[8:11], v[16:31]
    ds_read_b128 a[4:7], v9 offset:4096
    ds_read_b64_tr_b16 a[16:17], v13 offset:8192
    ds_read_b64_tr_b16 a[18:19], v13 offset:9216
    s_waitcnt lgkmcnt(3)
    v_mfma_f32_32x32x16_bf16 v[16:31], a[12:15], a[0:3], v[16:31]
    ds_read_b128 a[8:11], v9 offset:6144
    ds_read_b64_tr_b16 a[20:21], v13 offset:12288
    ds_read_b64_tr_b16 a[22:23], v13 offset:13312
    s_waitcnt lgkmcnt(3)
    s_waitcnt vmcnt(4)
    s_barrier
    v_mfma_f32_32x32x16_bf16 v[16:31], a[16:19], a[4:7], v[16:31]
    ds_read_b128 a[0:3], v9 offset:32768
    ds_read_b64_tr_b16 a[12:13], v13 offset:32768
    ds_read_b64_tr_b16 a[14:15], v13 offset:33792
    s_mov_b32 s31, 40960
    s_add_u32 m0, s36, 32768
    s_nop 0
    buffer_load_dwordx4 v15, s[20:23], s31 offen lds
    s_mov_b32 s31, 655360
    s_add_u32 m0, s30, 32768
    s_nop 0
    buffer_load_dwordx4 v10, s[12:15], s31 offen lds
    s_waitcnt lgkmcnt(3)
    v_mfma_f32_32x32x16_bf16 v[16:31], a[20:23], a[8:11], v[16:31]
    ds_read_b128 a[4:7], v9 offset:34816
    ds_read_b64_tr_b16 a[16:17], v13 offset:36864
    ds_read_b64_tr_b16 a[18:19], v13 offset:37888
    s_mov_b32 s31, 41984
    s_add_u32 m0, s36, 33792
    s_nop 0
    buffer_load_dwordx4 v15, s[20:23], s31 offen lds
    s_mov_b32 s31, 663552
    s_add_u32 m0, s30, 33792
    s_nop 0
    buffer_load_dwordx4 v10, s[12:15], s31 offen lds
    s_waitcnt lgkmcnt(3)
    v_mfma_f32_32x32x16_bf16 v[16:31], a[12:15], a[0:3], v[16:31]
    ds_read_b128 a[8:11], v9 offset:36864
    ds_read_b64_tr_b16 a[20:21], v13 offset:40960
    ds_read_b64_tr_b16 a[22:23], v13 offset:41984
    s_waitcnt lgkmcnt(3)
    v_mfma_f32_32x32x16_bf16 v[16:31], a[16:19], a[4:7], v[16:31]
    ds_read_b128 a[0:3], v9 offset:38912
    ds_read_b64_tr_b16 a[12:13], v13 offset:45056
    ds_read_b64_tr_b16 a[14:15], v13 offset:46080
    s_waitcnt lgkmcnt(3)
    s_waitcnt vmcnt(4)
    s_barrier
    v_mfma_f32_32x32x16_bf16 v[16:31], a[20:23], a[8:11], v[16:31]
    ds_read_b128 a[4:7], v4 offset:0
    ds_read_b64_tr_b16 a[16:17], v12 offset:0
    ds_read_b64_tr_b16 a[18:19], v12 offset:1024
    s_mov_b32 s31, 49152
    s_add_u32 m0, s36, 65536
    s_nop 0
    buffer_load_dwordx4 v15, s[20:23], s31 offen lds
    s_mov_b32 s31, 786432
    s_add_u32 m0, s30, 65536
    s_nop 0
    buffer_load_dwordx4 v10, s[12:15], s31 offen lds
    s_waitcnt lgkmcnt(3)
    v_mfma_f32_32x32x16_bf16 v[16:31], a[12:15], a[0:3], v[16:31]
    ds_read_b128 a[8:11], v4 offset:2048
    ds_read_b64_tr_b16 a[20:21], v12 offset:4096
    ds_read_b64_tr_b16 a[22:23], v12 offset:5120
    s_mov_b32 s31, 50176
    s_add_u32 m0, s36, 66560
    s_nop 0
    buffer_load_dwordx4 v15, s[20:23], s31 offen lds
    s_mov_b32 s31, 794624
    s_add_u32 m0, s30, 66560
    s_nop 0
    buffer_load_dwordx4 v10, s[12:15], s31 offen lds
    s_waitcnt lgkmcnt(3)
    v_mfma_f32_32x32x16_bf16 v[16:31], a[16:19], a[4:7], v[16:31]
    ds_read_b128 a[0:3], v4 offset:4096
    ds_read_b64_tr_b16 a[12:13], v12 offset:8192
    ds_read_b64_tr_b16 a[14:15], v12 offset:9216
    s_waitcnt lgkmcnt(3)
    v_mfma_f32_32x32x16_bf16 v[16:31], a[20:23], a[8:11], v[16:31]
    ds_read_b128 a[4:7], v4 offset:6144
    ds_read_b64_tr_b16 a[16:17], v12 offset:12288
    ds_read_b64_tr_b16 a[18:19], v12 offset:13312
    s_waitcnt lgkmcnt(3)
    s_waitcnt vmcnt(4)
    s_barrier
    v_mfma_f32_32x32x16_bf16 v[16:31], a[12:15], a[0:3], v[16:31]
    ds_read_b128 a[8:11], v4 offset:32768
    ds_read_b64_tr_b16 a[20:21], v12 offset:32768
    ds_read_b64_tr_b16 a[22:23], v12 offset:33792
    s_mov_b32 s31, 57344
    s_add_u32 m0, s36, 98304
    s_nop 0
    buffer_load_dwordx4 v15, s[20:23], s31 offen lds
    s_mov_b32 s31, 917504
    s_add_u32 m0, s30, 98304
    s_nop 0
    buffer_load_dwordx4 v10, s[12:15], s31 offen lds
    s_waitcnt lgkmcnt(3)
    v_mfma_f32_32x32x16_bf16 v[16:31], a[16:19], a[4:7], v[16:31]
    ds_read_b128 a[0:3], v4 offset:34816
    ds_read_b64_tr_b16 a[12:13], v12 offset:36864
    ds_read_b64_tr_b16 a[14:15], v12 offset:37888
    s_mov_b32 s31, 58368
    s_add_u32 m0, s36, 99328
    s_nop 0
    buffer_load_dwordx4 v15, s[20:23], s31 offen lds
    s_mov_b32 s31, 925696
    s_add_u32 m0, s30, 99328
    s_nop 0
    buffer_load_dwordx4 v10, s[12:15], s31 offen lds
    s_waitcnt lgkmcnt(3)
    v_mfma_f32_32x32x16_bf16 v[16:31], a[20:23], a[8:11], v[16:31]
    ds_read_b128 a[4:7], v4 offset:36864
    ds_read_b64_tr_b16 a[16:17], v12 offset:40960
    ds_read_b64_tr_b16 a[18:19], v12 offset:41984
    s_waitcnt lgkmcnt(3)
    v_mfma_f32_32x32x16_bf16 v[16:31], a[12:15], a[0:3], v[16:31]
    ds_read_b128 a[8:11], v4 offset:38912
    ds_read_b64_tr_b16 a[20:21], v12 offset:45056
    ds_read_b64_tr_b16 a[22:23], v12 offset:46080
    s_waitcnt lgkmcnt(3)
    s_waitcnt vmcnt(4)
    s_barrier
    v_mfma_f32_32x32x16_bf16 v[16:31], a[16:19], a[4:7], v[16:31]
    ds_read_b128 a[0:3], v9 offset:0
    ds_read_b64_tr_b16 a[12:13], v13 offset:0
    ds_read_b64_tr_b16 a[14:15], v13 offset:1024
    s_mov_b32 s31, 65536
    s_add_u32 m0, s36, 0
    s_nop 0
    buffer_load_dwordx4 v15, s[20:23], s31 offen lds
    s_mov_b32 s31, 1048576
    s_add_u32 m0, s30, 0
    s_nop 0
    buffer_load_dwordx4 v10, s[12:15], s31 offen lds
    s_waitcnt lgkmcnt(3)
    v_mfma_f32_32x32x16_bf16 v[16:31], a[20:23], a[8:11], v[16:31]
    ds_read_b128 a[4:7], v9 offset:2048
    ds_read_b64_tr_b16 a[16:17], v13 offset:4096
    ds_read_b64_tr_b16 a[18:19], v13 offset:5120
    s_mov_b32 s31, 66560
    s_add_u32 m0, s36, 1024
    s_nop 0
    buffer_load_dwordx4 v15, s[20:23], s31 offen lds
    s_mov_b32 s31, 1056768
    s_add_u32 m0, s30, 1024
    s_nop 0
    buffer_load_dwordx4 v10, s[12:15], s31 offen lds
    s_waitcnt lgkmcnt(3)
    v_mfma_f32_32x32x16_bf16 v[16:31], a[12:15], a[0:3], v[16:31]
    ds_read_b128 a[8:11], v9 offset:4096
    ds_read_b64_tr_b16 a[20:21], v13 offset:8192
    ds_read_b64_tr_b16 a[22:23], v13 offset:9216
    s_waitcnt lgkmcnt(3)
    v_mfma_f32_32x32x16_bf16 v[16:31], a[16:19], a[4:7], v[16:31]
    ds_read_b128 a[0:3], v9 offset:6144
    ds_read_b64_tr_b16 a[12:13], v13 offset:12288
    ds_read_b64_tr_b16 a[14:15], v13 offset:13312
    s_waitcnt lgkmcnt(3)
    s_waitcnt vmcnt(4)
    s_barrier
    v_mfma_f32_32x32x16_bf16 v[16:31], a[20:23], a[8:11], v[16:31]
    ds_read_b128 a[4:7], v9 offset:32768
    ds_read_b64_tr_b16 a[16:17], v13 offset:32768
    ds_read_b64_tr_b16 a[18:19], v13 offset:33792
    s_mov_b32 s31, 73728
    s_add_u32 m0, s36, 32768
    s_nop 0
    buffer_load_dwordx4 v15, s[20:23], s31 offen lds
    s_mov_b32 s31, 1179648
    s_add_u32 m0, s30, 32768
    s_nop 0
    buffer_load_dwordx4 v10, s[12:15], s31 offen lds
    s_waitcnt lgkmcnt(3)
    v_mfma_f32_32x32x16_bf16 v[16:31], a[12:15], a[0:3], v[16:31]
    ds_read_b128 a[8:11], v9 offset:34816
    ds_read_b64_tr_b16 a[20:21], v13 offset:36864
    ds_read_b64_tr_b16 a[22:23], v13 offset:37888
    s_mov_b32 s31, 74752
    s_add_u32 m0, s36, 33792
    s_nop 0
    buffer_load_dwordx4 v15, s[20:23], s31 offen lds
    s_mov_b32 s31, 1187840
    s_add_u32 m0, s30, 33792
    s_nop 0
    buffer_load_dwordx4 v10, s[12:15], s31 offen lds
    s_waitcnt lgkmcnt(3)
    v_mfma_f32_32x32x16_bf16 v[16:31], a[16:19], a[4:7], v[16:31]
    ds_read_b128 a[0:3], v9 offset:36864
    ds_read_b64_tr_b16 a[12:13], v13 offset:40960
    ds_read_b64_tr_b16 a[14:15], v13 offset:41984
    s_waitcnt lgkmcnt(3)
    v_mfma_f32_32x32x16_bf16 v[16:31], a[20:23], a[8:11], v[16:31]
    ds_read_b128 a[4:7], v9 offset:38912
    ds_read_b64_tr_b16 a[16:17], v13 offset:45056
    ds_read_b64_tr_b16 a[18:19], v13 offset:46080
    s_waitcnt lgkmcnt(3)
    s_waitcnt vmcnt(4)
    s_barrier
    v_mfma_f32_32x32x16_bf16 v[16:31], a[12:15], a[0:3], v[16:31]
    ds_read_b128 a[8:11], v4 offset:0
    ds_read_b64_tr_b16 a[20:21], v12 offset:0
    ds_read_b64_tr_b16 a[22:23], v12 offset:1024
    s_mov_b32 s31, 81920
    s_add_u32 m0, s36, 65536
    s_nop 0
    buffer_load_dwordx4 v15, s[20:23], s31 offen lds
    s_mov_b32 s31, 1310720
    s_add_u32 m0, s30, 65536
    s_nop 0
    buffer_load_dwordx4 v10, s[12:15], s31 offen lds
    s_waitcnt lgkmcnt(3)
    v_mfma_f32_32x32x16_bf16 v[16:31], a[16:19], a[4:7], v[16:31]
    ds_read_b128 a[0:3], v4 offset:2048
    ds_read_b64_tr_b16 a[12:13], v12 offset:4096
    ds_read_b64_tr_b16 a[14:15], v12 offset:5120
    s_mov_b32 s31, 82944
    s_add_u32 m0, s36, 66560
    s_nop 0
    buffer_load_dwordx4 v15, s[20:23], s31 offen lds
    s_mov_b32 s31, 1318912
    s_add_u32 m0, s30, 66560
    s_nop 0
    buffer_load_dwordx4 v10, s[12:15], s31 offen lds
    s_waitcnt lgkmcnt(3)
    v_mfma_f32_32x32x16_bf16 v[16:31], a[20:23], a[8:11], v[16:31]
    ds_read_b128 a[4:7], v4 offset:4096
    ds_read_b64_tr_b16 a[16:17], v12 offset:8192
    ds_read_b64_tr_b16 a[18:19], v12 offset:9216
    s_waitcnt lgkmcnt(3)
    v_mfma_f32_32x32x16_bf16 v[16:31], a[12:15], a[0:3], v[16:31]
    ds_read_b128 a[8:11], v4 offset:6144
    ds_read_b64_tr_b16 a[20:21], v12 offset:12288
    ds_read_b64_tr_b16 a[22:23], v12 offset:13312
    s_waitcnt lgkmcnt(3)
    s_waitcnt vmcnt(4)
    s_barrier
    v_mfma_f32_32x32x16_bf16 v[16:31], a[16:19], a[4:7], v[16:31]
    ds_read_b128 a[0:3], v4 offset:32768
    ds_read_b64_tr_b16 a[12:13], v12 offset:32768
    ds_read_b64_tr_b16 a[14:15], v12 offset:33792
    s_waitcnt lgkmcnt(3)
    v_mfma_f32_32x32x16_bf16 v[16:31], a[20:23], a[8:11], v[16:31]
    ds_read_b128 a[4:7], v4 offset:34816
    ds_read_b64_tr_b16 a[16:17], v12 offset:36864
    ds_read_b64_tr_b16 a[18:19], v12 offset:37888
    s_waitcnt lgkmcnt(3)
    v_mfma_f32_32x32x16_bf16 v[16:31], a[12:15], a[0:3], v[16:31]
    ds_read_b128 a[8:11], v4 offset:36864
    ds_read_b64_tr_b16 a[20:21], v12 offset:40960
    ds_read_b64_tr_b16 a[22:23], v12 offset:41984
    s_waitcnt lgkmcnt(3)
    v_mfma_f32_32x32x16_bf16 v[16:31], a[16:19], a[4:7], v[16:31]
    ds_read_b128 a[0:3], v4 offset:38912
    ds_read_b64_tr_b16 a[12:13], v12 offset:45056
    ds_read_b64_tr_b16 a[14:15], v12 offset:46080
    s_waitcnt lgkmcnt(3)
    s_waitcnt vmcnt(0)
    s_barrier
    v_mfma_f32_32x32x16_bf16 v[16:31], a[20:23], a[8:11], v[16:31]
    ds_read_b128 a[4:7], v9 offset:0
    ds_read_b64_tr_b16 a[16:17], v13 offset:0
    ds_read_b64_tr_b16 a[18:19], v13 offset:1024
    s_waitcnt lgkmcnt(3)
    v_mfma_f32_32x32x16_bf16 v[16:31], a[12:15], a[0:3], v[16:31]
    ds_read_b128 a[8:11], v9 offset:2048
    ds_read_b64_tr_b16 a[20:21], v13 offset:4096
    ds_read_b64_tr_b16 a[22:23], v13 offset:5120
    s_waitcnt lgkmcnt(3)
    v_mfma_f32_32x32x16_bf16 v[16:31], a[16:19], a[4:7], v[16:31]
    ds_read_b128 a[0:3], v9 offset:4096
    ds_read_b64_tr_b16 a[12:13], v13 offset:8192
    ds_read_b64_tr_b16 a[14:15], v13 offset:9216
    s_waitcnt lgkmcnt(3)
    v_mfma_f32_32x32x16_bf16 v[16:31], a[20:23], a[8:11], v[16:31]
    s_waitcnt lgkmcnt(0)
    v_mfma_f32_32x32x16_bf16 v[16:31], a[12:15], a[0:3], v[16:31]
    s_nop 7
    s_nop 7
    s_barrier
    s_lshl_b32 s28, s24, 11
    s_add_u32 s28, s28, 0
    v_lshlrev_b32 v14, 4, v1
    v_add_u32 v14, s28, v14
    s_xor_b32 s28, s28, 0x2000
    v_lshlrev_b32 v15, 4, v1
    v_add_u32 v15, s28, v15
    s_cmp_eq_u32 s35, 0
    s_cbranch_scc0 PH1_2
    ds_write_b128 v14, v[24:27]
    ds_write_b128 v14, v[28:31] offset:1024
    v_mov_b32 v40, v16
    v_mov_b32 v41, v17
    v_mov_b32 v42, v18
    v_mov_b32 v43, v19
    v_mov_b32 v44, v20
    v_mov_b32 v45, v21
    v_mov_b32 v46, v22
    v_mov_b32 v47, v23
    s_branch PH2_2
PH1_2:
    ds_write_b128 v14, v[16:19]
    ds_write_b128 v14, v[20:23] offset:1024
    v_mov_b32 v40, v24
    v_mov_b32 v41, v25
    v_mov_b32 v42, v26
    v_mov_b32 v43, v27
    v_mov_b32 v44, v28
    v_mov_b32 v45, v29
    v_mov_b32 v46, v30
    v_mov_b32 v47, v31
PH2_2:
    s_waitcnt lgkmcnt(0)
    s_barrier
    ds_read_b128 v[16:19], v15
    ds_read_b128 v[20:23], v15 offset:1024
    s_waitcnt lgkmcnt(0)
    v_add_f32 v40, v40, v16
    v_add_f32 v41, v41, v17
    v_add_f32 v42, v42, v18
    v_add_f32 v43, v43, v19
    v_add_f32 v44, v44, v20
    v_add_f32 v45, v45, v21
    v_add_f32 v46, v46, v22
    v_add_f32 v47, v47, v23
    v_lshlrev_b32 v48, 16, v32
    v_and_b32 v49, 0xffff0000, v32
    v_add_f32 v48, v48, v40
    v_add_f32 v49, v49, v41
    v_cvt_pk_bf16_f32 v32, v48, v49
    v_lshlrev_b32 v48, 16, v33
    v_and_b32 v49, 0xffff0000, v33
    v_add_f32 v48, v48, v42
    v_add_f32 v49, v49, v43
    v_cvt_pk_bf16_f32 v33, v48, v49
    v_lshlrev_b32 v48, 16, v34
    v_and_b32 v49, 0xffff0000, v34
    v_add_f32 v48, v48, v44
    v_add_f32 v49, v49, v45
    v_cvt_pk_bf16_f32 v34, v48, v49
    v_lshlrev_b32 v48, 16, v35
    v_and_b32 v49, 0xffff0000, v35
    v_add_f32 v48, v48, v46
    v_add_f32 v49, v49, v47
    v_cvt_pk_bf16_f32 v35, v48, v49
    s_lshl_b32 s28, s27, 5
    v_add_u32 v8, s28, v2
    v_lshlrev_b32 v9, 10, v8
    v_lshl_add_u32 v9, v3, 3, v9
    s_lshl_b32 s29, s26, 7
    s_lshl_b32 s28, s33, 6
    s_add_u32 s29, s29, s28
    s_lshl_b32 s28, s35, 5
    s_add_u32 s29, s29, s28
    v_add_u32 v9, s29, v9
    buffer_store_dwordx2 v[32:33], v9, s[16:19], 0 offen offset:0
    buffer_store_dwordx2 v[34:35], v9, s[16:19], 0 offen offset:16
K4_END:
    s_endpgm
.section .rodata,"a"
.p2align 6
.amdhsa_kernel k1_qkv_kernel
  .amdhsa_next_free_vgpr 216
  .amdhsa_next_free_sgpr 96
  .amdhsa_accum_offset 176
  .amdhsa_group_segment_fixed_size 0
  .amdhsa_kernarg_size 80
  .amdhsa_user_sgpr_count 2
  .amdhsa_user_sgpr_kernarg_segment_ptr 1
  .amdhsa_system_sgpr_workgroup_id_x 1
.end_amdhsa_kernel
.p2align 6
.amdhsa_kernel kr_reduce_kernel
  .amdhsa_next_free_vgpr 64
  .amdhsa_next_free_sgpr 96
  .amdhsa_accum_offset 64
  .amdhsa_group_segment_fixed_size 0
  .amdhsa_kernarg_size 80
  .amdhsa_user_sgpr_count 2
  .amdhsa_user_sgpr_kernarg_segment_ptr 1
  .amdhsa_system_sgpr_workgroup_id_x 1
.end_amdhsa_kernel
.p2align 6
.amdhsa_kernel k2_attnout_kernel
  .amdhsa_next_free_vgpr 208
  .amdhsa_next_free_sgpr 96
  .amdhsa_accum_offset 176
  .amdhsa_group_segment_fixed_size 0
  .amdhsa_kernarg_size 80
  .amdhsa_user_sgpr_count 2
  .amdhsa_user_sgpr_kernarg_segment_ptr 1
  .amdhsa_system_sgpr_workgroup_id_x 1
.end_amdhsa_kernel
.p2align 6
.amdhsa_kernel k3_gateup_kernel
  .amdhsa_next_free_vgpr 256
  .amdhsa_next_free_sgpr 96
  .amdhsa_accum_offset 208
  .amdhsa_group_segment_fixed_size 0
  .amdhsa_kernarg_size 80
  .amdhsa_user_sgpr_count 2
  .amdhsa_user_sgpr_kernarg_segment_ptr 1
  .amdhsa_system_sgpr_workgroup_id_x 1
.end_amdhsa_kernel
.p2align 6
.amdhsa_kernel sequential_preLN__linear_attn_block__glu_gated_bilinear__prompt_kernel
  .amdhsa_next_free_vgpr 96
  .amdhsa_next_free_sgpr 96
  .amdhsa_accum_offset 64
  .amdhsa_group_segment_fixed_size 0
  .amdhsa_kernarg_size 80
  .amdhsa_user_sgpr_count 2
  .amdhsa_user_sgpr_kernarg_segment_ptr 1
  .amdhsa_system_sgpr_workgroup_id_x 1
.end_amdhsa_kernel
```
